```python
import torch

def _softmax(x, axis=-1):
    return torch.softmax(x, dim=axis)
def _gelu(x):
    return torch.nn.functional.gelu(x, approximate="tanh")
def _silu(x):
    return torch.nn.functional.silu(x)
def _sigmoid(x):
    return torch.sigmoid(x)
def _layernorm(x, axis=-1, eps=1e-5):
    m = x.mean(dim=axis, keepdim=True)
    v = x.var(dim=axis, keepdim=True, unbiased=False)
    return (x - m) / torch.sqrt(v + eps)
def _scatter_add(tgt, idx, src, axis=0):
    return tgt.clone().index_add_(axis, idx, src)
def _segment_sum(src, seg, n):
    out = torch.zeros((n,) + src.shape[1:], dtype=src.dtype)
    return out.index_add_(0, seg, src)
def _pad(x, pw):
    flat = tuple(v for pair in reversed(pw) for v in pair)
    return torch.nn.functional.pad(x, flat)

kernel_name = 'sequential_preLN__gqa_block_cached__dense_activation_silu__decode'

def setup_inputs():

    _w = (lambda a: (lambda t: t.to(torch.bfloat16) if t.is_floating_point() else t)(torch.as_tensor(a)))
    def _A_setup():
        B, Sq, D = 1, 1, 1024
        Hq, Hkv, Sk, Dh = 32, 4, 65536, 128
        assert Hq % Hkv == 0, (Hq, Hkv)
        return {
            "x": _w((lambda *s: torch.randn(*s, dtype=torch.bfloat16) * 0.05)(B, Sq, D)),
            "k_cache": _w((lambda *s: torch.randn(*s, dtype=torch.bfloat16) * 3.2)(B, Hkv, Sk, Dh)),
            "v_cache": _w((lambda *s: torch.randn(*s, dtype=torch.bfloat16) * 0.8)(B, Hkv, Sk, Dh)),
            "wq": _w((lambda *s: torch.randn(*s, dtype=torch.bfloat16) * 3.2)(D, Hq * Dh) * (D ** -0.5)),
            "wo": _w((lambda *s: torch.randn(*s, dtype=torch.bfloat16) * 0.8)(Hq * Dh, D) * ((Hq * Dh) ** -0.5)),
        }
    _A_in = _A_setup()

    def _B_setup():
        B, S, D, F = 1, 1, 1024, 3584
        return {
            "x": _w((lambda *s: torch.randn(*s, dtype=torch.bfloat16) * 0.05)(B, S, D)),
            "w1": _w((lambda *s: torch.randn(*s, dtype=torch.bfloat16) * 3.2)(D, F) * (D ** -0.5)),
            "w2": _w((lambda *s: torch.randn(*s, dtype=torch.bfloat16) * 0.8)(F, D) * (F ** -0.5)),
        }
    _B_in = _B_setup()

    return {
        "A_x": _A_in["x"],
        "A_k_cache": _A_in["k_cache"],
        "A_v_cache": _A_in["v_cache"],
        "A_wq": _A_in["wq"],
        "A_wo": _A_in["wo"],
        "B_x": _B_in["x"],
        "B_w1": _B_in["w1"],
        "B_w2": _B_in["w2"],
    }

def reference(A_x, A_k_cache, A_v_cache, A_wq, A_wo, B_x, B_w1, B_w2):
    def _A_ref(x, k_cache, v_cache, wq, wo):
        B, Sq, D = x.shape
        Hq, Dh = 32, 128
        Hkv = k_cache.shape[1]
        rep = Hq // Hkv
        q = (lambda x, *d: x.permute(*d))((x @ wq).reshape(B, Sq, Hq, Dh), 0, 2, 1, 3)
        k = (lambda x, n, axis: torch.repeat_interleave(x, n, dim=axis))(k_cache, rep, axis=1)
        v = (lambda x, n, axis: torch.repeat_interleave(x, n, dim=axis))(v_cache, rep, axis=1)
        scores = torch.einsum("bhqd,bhkd->bhqk", q, k) * (Dh ** -0.5)
        p = _softmax(scores, axis=-1)
        o = torch.einsum("bhqk,bhkd->bhqd", p, v)
        return (lambda x, *d: x.permute(*d))(o, 0, 2, 1, 3).reshape(B, Sq, Hq * Dh) @ wo

    def _B_ref(x, w1, w2):
        h = torch.einsum("bsd,df->bsf", x, w1)
        h = _silu(h)
        out = torch.einsum("bsf,fd->bsd", h, w2)
        return out

    x = A_x
    h = x + _A_ref(_layernorm(x, axis=-1), A_k_cache, A_v_cache, A_wq, A_wo)
    h2 = h + _B_ref(_layernorm(h, axis=-1), B_w1, B_w2)
    return h2
```

```asm
; @launch grid=(256,1,1) block=(512,1,1) lds=45056
.amdgcn_target "amdgcn-amd-amdhsa--gfx950"
.text
.globl sequential_preLN__gqa_block_cached__dense_activation_silu__decode_kernel
.p2align 8
.type sequential_preLN__gqa_block_cached__dense_activation_silu__decode_kernel,@function
sequential_preLN__gqa_block_cached__dense_activation_silu__decode_kernel:
    s_cmp_ge_u32 s2, 256
    s_cbranch_scc1 L_end_1_sequential_p
    s_load_dwordx16 s[44:59], s[0:1], 0
    s_load_dwordx2 s[60:61], s[0:1], 64
    s_load_dwordx2 s[64:65], s[0:1], 80
    v_lshrrev_b32 v6, 6, v0
    v_and_b32 v1, 63, v0
    v_readfirstlane_b32 s3, v6
    v_lshrrev_b32 v2, 4, v1
    v_and_b32 v3, 15, v1
    v_lshlrev_b32 v6, 4, v1
    v_lshrrev_b32 v7, 3, v1
    v_lshlrev_b32 v10, 3, v7
    v_and_b32 v11, 1, v1
    v_lshlrev_b32 v8, 15, v7
    v_and_b32 v9, 7, v1
    v_lshl_add_u32 v8, v9, 4, v8
    v_lshrrev_b32 v7, 1, v1
    v_and_b32 v4, 3, v1
    v_lshlrev_b32 v4, 10, v4
    v_bfe_u32 v12, v1, 2, 1
    v_lshl_add_u32 v4, v12, 8, v4
    v_lshl_add_u32 v4, v2, 4, v4
    v_bfe_u32 v12, v1, 3, 1
    v_lshl_add_u32 v4, v12, 6, v4
    s_lshr_b32 s94, s2, 6
    s_lshl_b32 s95, s94, 4
    s_and_b32 s96, s2, 15
    s_add_u32 s95, s95, s96
    s_bfe_u32 s96, s2, 0x20004
    s_lshl_b32 s96, s96, 8
    s_lshl_b32 s97, s3, 5
    s_add_u32 s96, s96, s97
    s_lshl_b32 s97, s96, 13
    s_lshl_b32 s98, s95, 7
    s_add_u32 s97, s97, s98
    s_lshl_b32 s98, s96, 1
    s_waitcnt lgkmcnt(0)
    s_mov_b32 s16, s50
    s_and_b32 s17, s51, 0xffff
    s_mov_b32 s18, 0x800000
    s_mov_b32 s19, 0x20000
    buffer_load_dwordx4 v[224:227], v8, s[16:19], s97 offen nt
    s_add_u32 s97, s97, 8192
    buffer_load_dwordx4 v[228:231], v8, s[16:19], s97 offen nt
    s_add_u32 s97, s97, 8192
    buffer_load_dwordx4 v[232:235], v8, s[16:19], s97 offen nt
    s_add_u32 s97, s97, 8192
    buffer_load_dwordx4 v[236:239], v8, s[16:19], s97 offen nt
    s_mov_b32 s4, s44
    s_and_b32 s5, s45, 0xffff
    s_mov_b32 s6, 0x800
    s_mov_b32 s7, 0x20000
    buffer_load_dwordx4 v[240:243], v6, s[4:7], 0 offen
    buffer_load_dwordx4 v[244:247], v6, s[4:7], 0 offen offset:1024
    buffer_load_dwordx2 v[248:249], v10, s[4:7], s98 offen
    s_add_u32 s66, s64, 0x480000
    s_addc_u32 s67, s65, 0
    s_load_dwordx2 s[68:69], s[66:67], 0
    s_mov_b32 s8, s46
    s_and_b32 s9, s47, 0xffff
    s_mov_b32 s10, 0x4000000
    s_mov_b32 s11, 0x20000
    s_mov_b32 s12, s48
    s_and_b32 s13, s49, 0xffff
    s_mov_b32 s14, 0x4000000
    s_mov_b32 s15, 0x20000
    s_mov_b32 s20, s52
    s_and_b32 s21, s53, 0xffff
    s_mov_b32 s22, 0x800000
    s_mov_b32 s23, 0x20000
    s_mov_b32 s24, s56
    s_and_b32 s25, s57, 0xffff
    s_mov_b32 s26, 0x700000
    s_mov_b32 s27, 0x20000
    s_mov_b32 s28, s58
    s_and_b32 s29, s59, 0xffff
    s_mov_b32 s30, 0x700000
    s_mov_b32 s31, 0x20000
    s_mov_b32 s32, s60
    s_and_b32 s33, s61, 0xffff
    s_mov_b32 s34, 0x800
    s_mov_b32 s35, 0x20000
    s_mov_b32 s36, s64
    s_and_b32 s37, s65, 0xffff
    s_mov_b32 s38, 0x10000000
    s_mov_b32 s39, 0x20000
    s_mov_b32 s45, s94
    s_mov_b32 s46, s95
    s_mov_b32 s60, 0x3fb8aa3b
    s_mov_b32 s61, 0x3db504f3
    s_mov_b32 s62, 0x05040100
    s_mov_b32 s63, 0x07060302
    s_mov_b32 s64, 0xffff0000
    s_lshl_b32 s44, s45, 24
    s_and_b32 s48, s2, 7
    s_lshl_b32 s48, s48, 16
    s_add_u32 s44, s44, s48
    s_bfe_u32 s48, s2, 0x30003
    s_lshl_b32 s48, s48, 19
    s_add_u32 s44, s44, s48
    s_lshl_b32 s48, s3, 13
    s_add_u32 s44, s44, s48
    s_barrier
    s_and_b32 s48, s2, 63
    s_or_b32 s48, s48, s3
    s_cbranch_scc1 L_j1_3_sequential_p
    s_lshl_b32 s48, s45, 15
    s_add_u32 s48, s48, 0x200020
    s_mov_b64 exec, 1
    v_mov_b32 v32, 0
    v_mov_b32 v33, -1
    buffer_store_dword v33, v32, s[36:39], s48 offen sc1
    s_mov_b64 exec, -1
L_j1_3_sequential_p:
    s_add_u32 s50, s44, 0
    buffer_load_dwordx4 v[96:99], v4, s[8:11], s50 offen offset:0 nt
    buffer_load_dwordx4 v[100:103], v4, s[8:11], s50 offen offset:128 nt
    buffer_load_dwordx4 v[104:107], v4, s[8:11], s50 offen offset:512 nt
    buffer_load_dwordx4 v[108:111], v4, s[8:11], s50 offen offset:640 nt
    s_add_u32 s50, s44, 4096
    buffer_load_dwordx4 v[112:115], v4, s[8:11], s50 offen offset:0 nt
    buffer_load_dwordx4 v[116:119], v4, s[8:11], s50 offen offset:128 nt
    buffer_load_dwordx4 v[120:123], v4, s[8:11], s50 offen offset:512 nt
    buffer_load_dwordx4 v[124:127], v4, s[8:11], s50 offen offset:640 nt
    s_cmp_lg_u32 s3, 0
    s_cbranch_scc1 L_w0a_2_sequential_p
    s_setprio 3
L_w0a_2_sequential_p:
    s_waitcnt vmcnt(8)
    v_lshlrev_b32 v64, 16, v240
    v_and_b32 v65, s64, v240
    v_lshlrev_b32 v66, 16, v241
    v_and_b32 v67, s64, v241
    v_lshlrev_b32 v68, 16, v242
    v_and_b32 v69, s64, v242
    v_lshlrev_b32 v70, 16, v243
    v_and_b32 v71, s64, v243
    v_lshlrev_b32 v72, 16, v244
    v_and_b32 v73, s64, v244
    v_lshlrev_b32 v74, 16, v245
    v_and_b32 v75, s64, v245
    v_lshlrev_b32 v76, 16, v246
    v_and_b32 v77, s64, v246
    v_lshlrev_b32 v78, 16, v247
    v_and_b32 v79, s64, v247
    v_pk_add_f32 v[32:33], v[64:65], v[72:73]
    v_pk_add_f32 v[34:35], v[66:67], v[74:75]
    v_pk_add_f32 v[36:37], v[68:69], v[76:77]
    v_pk_add_f32 v[38:39], v[70:71], v[78:79]
    v_pk_add_f32 v[32:33], v[32:33], v[36:37]
    v_pk_add_f32 v[34:35], v[34:35], v[38:39]
    v_pk_add_f32 v[32:33], v[32:33], v[34:35]
    v_add_f32 v32, v32, v33
    s_nop 1
    v_add_f32_dpp v32, v32, v32 row_ror:1 row_mask:0xf bank_mask:0xf
    s_nop 1
    v_add_f32_dpp v32, v32, v32 row_ror:2 row_mask:0xf bank_mask:0xf
    s_nop 1
    v_add_f32_dpp v32, v32, v32 row_ror:4 row_mask:0xf bank_mask:0xf
    s_nop 1
    v_add_f32_dpp v32, v32, v32 row_ror:8 row_mask:0xf bank_mask:0xf
    v_mov_b32 v28, v32
    s_nop 1
    v_permlane16_swap_b32 v32, v28
    v_add_f32 v32, v32, v28
    v_mov_b32 v28, v32
    s_nop 1
    v_permlane32_swap_b32 v32, v28
    v_add_f32 v32, v32, v28
    v_mul_f32 v27, 0x3a800000, v32
    v_sub_f32 v64, v64, v27
    v_sub_f32 v65, v65, v27
    v_sub_f32 v66, v66, v27
    v_sub_f32 v67, v67, v27
    v_sub_f32 v68, v68, v27
    v_sub_f32 v69, v69, v27
    v_sub_f32 v70, v70, v27
    v_sub_f32 v71, v71, v27
    v_sub_f32 v72, v72, v27
    v_sub_f32 v73, v73, v27
    v_sub_f32 v74, v74, v27
    v_sub_f32 v75, v75, v27
    v_sub_f32 v76, v76, v27
    v_sub_f32 v77, v77, v27
    v_sub_f32 v78, v78, v27
    v_sub_f32 v79, v79, v27
    v_pk_mul_f32 v[32:33], v[64:65], v[64:65]
    v_pk_mul_f32 v[34:35], v[66:67], v[66:67]
    v_pk_fma_f32 v[32:33], v[68:69], v[68:69], v[32:33]
    v_pk_fma_f32 v[34:35], v[70:71], v[70:71], v[34:35]
    v_pk_fma_f32 v[32:33], v[72:73], v[72:73], v[32:33]
    v_pk_fma_f32 v[34:35], v[74:75], v[74:75], v[34:35]
    v_pk_fma_f32 v[32:33], v[76:77], v[76:77], v[32:33]
    v_pk_fma_f32 v[34:35], v[78:79], v[78:79], v[34:35]
    v_pk_add_f32 v[32:33], v[32:33], v[34:35]
    v_add_f32 v29, v32, v33
    s_nop 1
    v_add_f32_dpp v29, v29, v29 row_ror:1 row_mask:0xf bank_mask:0xf
    s_nop 1
    v_add_f32_dpp v29, v29, v29 row_ror:2 row_mask:0xf bank_mask:0xf
    s_nop 1
    v_add_f32_dpp v29, v29, v29 row_ror:4 row_mask:0xf bank_mask:0xf
    s_nop 1
    v_add_f32_dpp v29, v29, v29 row_ror:8 row_mask:0xf bank_mask:0xf
    v_mov_b32 v28, v29
    s_nop 1
    v_permlane16_swap_b32 v29, v28
    v_add_f32 v29, v29, v28
    v_mov_b32 v28, v29
    s_nop 1
    v_permlane32_swap_b32 v29, v28
    v_add_f32 v29, v29, v28
    v_mul_f32 v29, 0x3a800000, v29
    v_cvt_pk_bf16_f32 v28, v27, v29
    v_lshlrev_b32 v27, 16, v28
    v_and_b32 v29, s64, v28
    v_add_f32 v29, 0x3727c5ac, v29
    v_cvt_pk_bf16_f32 v28, v29, v29
    v_lshlrev_b32 v29, 16, v28
    v_sqrt_f32 v30, v29
    s_nop 0
    v_cvt_pk_bf16_f32 v28, v30, v30
    v_lshlrev_b32 v30, 16, v28
    v_rcp_f32 v31, v30
    v_lshlrev_b32 v48, 16, v248
    v_and_b32 v49, s64, v248
    v_lshlrev_b32 v50, 16, v249
    v_and_b32 v51, s64, v249
    v_sub_f32 v48, v48, v27
    v_sub_f32 v49, v49, v27
    v_sub_f32 v50, v50, v27
    v_sub_f32 v51, v51, v27
    v_cvt_pk_bf16_f32 v56, v48, v49
    v_cvt_pk_bf16_f32 v57, v50, v51
    v_lshlrev_b32 v48, 16, v56
    v_and_b32 v49, s64, v56
    v_lshlrev_b32 v50, 16, v57
    v_and_b32 v51, s64, v57
    v_mul_f32 v56, v48, v31
    v_mul_f32 v57, v49, v31
    v_mul_f32 v58, v50, v31
    v_mul_f32 v59, v51, v31
    v_fma_f32 v48, -v56, v30, v48
    v_fma_f32 v49, -v57, v30, v49
    v_fma_f32 v50, -v58, v30, v50
    v_fma_f32 v51, -v59, v30, v51
    v_fma_f32 v48, v48, v31, v56
    v_fma_f32 v49, v49, v31, v57
    v_fma_f32 v50, v50, v31, v58
    v_fma_f32 v51, v51, v31, v59
    v_cvt_pk_bf16_f32 v56, v48, v49
    v_cvt_pk_bf16_f32 v57, v50, v51
    v_lshlrev_b32 v48, 16, v56
    v_and_b32 v49, s64, v56
    v_lshlrev_b32 v50, 16, v57
    v_and_b32 v51, s64, v57
    v_lshlrev_b32 v64, 16, v224
    v_and_b32 v65, s64, v224
    v_lshlrev_b32 v66, 16, v225
    v_and_b32 v67, s64, v225
    v_lshlrev_b32 v68, 16, v226
    v_and_b32 v69, s64, v226
    v_lshlrev_b32 v70, 16, v227
    v_and_b32 v71, s64, v227
    v_lshlrev_b32 v72, 16, v228
    v_and_b32 v73, s64, v228
    v_lshlrev_b32 v74, 16, v229
    v_and_b32 v75, s64, v229
    v_lshlrev_b32 v76, 16, v230
    v_and_b32 v77, s64, v230
    v_lshlrev_b32 v78, 16, v231
    v_and_b32 v79, s64, v231
    v_lshlrev_b32 v80, 16, v232
    v_and_b32 v81, s64, v232
    v_lshlrev_b32 v82, 16, v233
    v_and_b32 v83, s64, v233
    v_lshlrev_b32 v84, 16, v234
    v_and_b32 v85, s64, v234
    v_lshlrev_b32 v86, 16, v235
    v_and_b32 v87, s64, v235
    v_lshlrev_b32 v88, 16, v236
    v_and_b32 v89, s64, v236
    v_lshlrev_b32 v90, 16, v237
    v_and_b32 v91, s64, v237
    v_lshlrev_b32 v92, 16, v238
    v_and_b32 v93, s64, v238
    v_lshlrev_b32 v94, 16, v239
    v_and_b32 v95, s64, v239
    v_pk_mul_f32 v[32:33], v[64:65], v[48:49] op_sel:[0,0] op_sel_hi:[1,0]
    v_pk_mul_f32 v[34:35], v[66:67], v[48:49] op_sel:[0,0] op_sel_hi:[1,0]
    v_pk_mul_f32 v[36:37], v[68:69], v[48:49] op_sel:[0,0] op_sel_hi:[1,0]
    v_pk_mul_f32 v[38:39], v[70:71], v[48:49] op_sel:[0,0] op_sel_hi:[1,0]
    v_pk_fma_f32 v[32:33], v[72:73], v[48:49], v[32:33] op_sel:[0,1,0] op_sel_hi:[1,1,1]
    v_pk_fma_f32 v[34:35], v[74:75], v[48:49], v[34:35] op_sel:[0,1,0] op_sel_hi:[1,1,1]
    v_pk_fma_f32 v[36:37], v[76:77], v[48:49], v[36:37] op_sel:[0,1,0] op_sel_hi:[1,1,1]
    v_pk_fma_f32 v[38:39], v[78:79], v[48:49], v[38:39] op_sel:[0,1,0] op_sel_hi:[1,1,1]
    v_pk_fma_f32 v[32:33], v[80:81], v[50:51], v[32:33] op_sel:[0,0,0] op_sel_hi:[1,0,1]
    v_pk_fma_f32 v[34:35], v[82:83], v[50:51], v[34:35] op_sel:[0,0,0] op_sel_hi:[1,0,1]
    v_pk_fma_f32 v[36:37], v[84:85], v[50:51], v[36:37] op_sel:[0,0,0] op_sel_hi:[1,0,1]
    v_pk_fma_f32 v[38:39], v[86:87], v[50:51], v[38:39] op_sel:[0,0,0] op_sel_hi:[1,0,1]
    v_pk_fma_f32 v[32:33], v[88:89], v[50:51], v[32:33] op_sel:[0,1,0] op_sel_hi:[1,1,1]
    v_pk_fma_f32 v[34:35], v[90:91], v[50:51], v[34:35] op_sel:[0,1,0] op_sel_hi:[1,1,1]
    v_pk_fma_f32 v[36:37], v[92:93], v[50:51], v[36:37] op_sel:[0,1,0] op_sel_hi:[1,1,1]
    v_pk_fma_f32 v[38:39], v[94:95], v[50:51], v[38:39] op_sel:[0,1,0] op_sel_hi:[1,1,1]
    s_nop 0
    v_permlane32_swap_b32 v32, v36
    v_permlane32_swap_b32 v33, v37
    v_permlane32_swap_b32 v34, v38
    v_permlane32_swap_b32 v35, v39
    v_pk_add_f32 v[32:33], v[32:33], v[36:37]
    v_pk_add_f32 v[34:35], v[34:35], v[38:39]
    s_nop 1
    v_permlane16_swap_b32 v32, v34
    v_permlane16_swap_b32 v33, v35
    v_pk_add_f32 v[32:33], v[32:33], v[34:35]
    s_nop 1
    v_add_f32_dpp v32, v32, v32 row_ror:8 row_mask:0xf bank_mask:0xf
    v_add_f32_dpp v33, v33, v33 row_ror:8 row_mask:0xf bank_mask:0xf
    v_and_b32 v9, 7, v1
    v_lshlrev_b32 v9, 5, v9
    v_lshl_add_u32 v9, v2, 3, v9
    s_lshl_b32 s48, s3, 8
    v_add_u32 v9, s48, v9
    ds_write_b64 v9, v[32:33] offset:0
    s_cmp_eq_u32 s3, 0
    s_cbranch_scc1 L_j2_7_sequential_p
    s_waitcnt lgkmcnt(0)
    s_barrier
    s_add_u32 s68, s68, 0x7f4a7c15
    s_addc_u32 s69, s69, 0x9e3779b9
    s_bfe_u64 s[100:101], s[68:69], 0x50000
    s_mov_b32 s96, s100
    s_bfe_u64 s[100:101], s[68:69], 0x50005
    s_mov_b32 s97, s100
    s_bfe_u64 s[100:101], s[68:69], 0x5000a
    s_mov_b32 s98, s100
    s_bfe_u64 s[100:101], s[68:69], 0x5000f
    s_mov_b32 s99, s100
    s_barrier
    s_branch L_j3_8_sequential_p
L_j2_7_sequential_p:
    s_waitcnt lgkmcnt(0)
    s_barrier
    s_add_u32 s68, s68, 0x7f4a7c15
    s_addc_u32 s69, s69, 0x9e3779b9
    s_bfe_u64 s[100:101], s[68:69], 0x50000
    s_mov_b32 s96, s100
    s_bfe_u64 s[100:101], s[68:69], 0x50005
    s_mov_b32 s97, s100
    s_bfe_u64 s[100:101], s[68:69], 0x5000a
    s_mov_b32 s98, s100
    s_bfe_u64 s[100:101], s[68:69], 0x5000f
    s_mov_b32 s99, s100
    s_mov_b64 exec, 0xffff
    ds_read_b128 v[64:67], v6 offset:0
    ds_read_b128 v[68:71], v6 offset:256
    ds_read_b128 v[72:75], v6 offset:512
    ds_read_b128 v[76:79], v6 offset:768
    ds_read_b128 v[80:83], v6 offset:1024
    ds_read_b128 v[84:87], v6 offset:1280
    ds_read_b128 v[88:91], v6 offset:1536
    ds_read_b128 v[92:95], v6 offset:1792
    s_lshl_b32 s48, s2, 8
    s_mov_b32 s49, 0xffffffe0
    v_mov_b32 v36, s96
    v_mov_b32 v37, s97
    v_mov_b32 v38, s98
    v_mov_b32 v39, s99
    s_waitcnt lgkmcnt(0)
    v_pk_add_f32 v[64:65], v[64:65], v[80:81]
    v_pk_add_f32 v[66:67], v[66:67], v[82:83]
    v_pk_add_f32 v[68:69], v[68:69], v[84:85]
    v_pk_add_f32 v[70:71], v[70:71], v[86:87]
    v_pk_add_f32 v[72:73], v[72:73], v[88:89]
    v_pk_add_f32 v[74:75], v[74:75], v[90:91]
    v_pk_add_f32 v[76:77], v[76:77], v[92:93]
    v_pk_add_f32 v[78:79], v[78:79], v[94:95]
    v_pk_add_f32 v[64:65], v[64:65], v[72:73]
    v_pk_add_f32 v[66:67], v[66:67], v[74:75]
    v_pk_add_f32 v[68:69], v[68:69], v[76:77]
    v_pk_add_f32 v[70:71], v[70:71], v[78:79]
    v_pk_add_f32 v[32:33], v[64:65], v[68:69]
    v_pk_add_f32 v[34:35], v[66:67], v[70:71]
    v_add_u32 v32, 0x10, v32
    v_add_u32 v33, 0x10, v33
    v_add_u32 v34, 0x10, v34
    v_add_u32 v35, 0x10, v35
    v_and_or_b32 v32, v32, s49, v36
    v_and_or_b32 v33, v33, s49, v37
    v_and_or_b32 v34, v34, s49, v38
    v_and_or_b32 v35, v35, s49, v39
    buffer_store_dwordx4 v[32:35], v6, s[36:39], s48 offen sc1
    s_mov_b64 exec, -1
    s_barrier
L_j3_8_sequential_p:
    s_setprio 3
    s_add_u32 s50, s44, 4194304
    buffer_load_dwordx4 v[128:131], v4, s[8:11], s50 offen offset:0 nt
    buffer_load_dwordx4 v[132:135], v4, s[8:11], s50 offen offset:128 nt
    buffer_load_dwordx4 v[136:139], v4, s[8:11], s50 offen offset:512 nt
    buffer_load_dwordx4 v[140:143], v4, s[8:11], s50 offen offset:640 nt
    s_add_u32 s50, s44, 4198400
    buffer_load_dwordx4 v[144:147], v4, s[8:11], s50 offen offset:0 nt
    buffer_load_dwordx4 v[148:151], v4, s[8:11], s50 offen offset:128 nt
    buffer_load_dwordx4 v[152:155], v4, s[8:11], s50 offen offset:512 nt
    buffer_load_dwordx4 v[156:159], v4, s[8:11], s50 offen offset:640 nt
    s_add_u32 s50, s44, 8388608
    buffer_load_dwordx4 v[160:163], v4, s[8:11], s50 offen offset:0 nt
    buffer_load_dwordx4 v[164:167], v4, s[8:11], s50 offen offset:128 nt
    buffer_load_dwordx4 v[168:171], v4, s[8:11], s50 offen offset:512 nt
    buffer_load_dwordx4 v[172:175], v4, s[8:11], s50 offen offset:640 nt
    s_lshl_b32 s48, s45, 14
    s_lshl_b32 s49, s3, 9
    s_add_u32 s48, s48, s49
    s_add_u32 s49, s48, 0x2000
    v_lshrrev_b32 v10, 5, v1
    v_and_b32 v9, 31, v1
    v_lshlrev_b32 v12, 12, v10
    v_lshl_add_u32 v12, v9, 4, v12
    buffer_load_dwordx4 v[64:67], v12, s[36:39], s48 offen sc1
    buffer_load_dwordx4 v[68:71], v12, s[36:39], s49 offen sc1
    s_add_u32 s50, s44, 8392704
    buffer_load_dwordx4 v[176:179], v4, s[8:11], s50 offen offset:0 nt
    buffer_load_dwordx4 v[180:183], v4, s[8:11], s50 offen offset:128 nt
    buffer_load_dwordx4 v[184:187], v4, s[8:11], s50 offen offset:512 nt
    buffer_load_dwordx4 v[188:191], v4, s[8:11], s50 offen offset:640 nt
    s_add_u32 s50, s44, 12582912
    buffer_load_dwordx4 v[192:195], v4, s[8:11], s50 offen offset:0 nt
    buffer_load_dwordx4 v[196:199], v4, s[8:11], s50 offen offset:128 nt
    buffer_load_dwordx4 v[200:203], v4, s[8:11], s50 offen offset:512 nt
    buffer_load_dwordx4 v[204:207], v4, s[8:11], s50 offen offset:640 nt
    s_add_u32 s50, s44, 12587008
    buffer_load_dwordx4 v[208:211], v4, s[8:11], s50 offen offset:0 nt
    buffer_load_dwordx4 v[212:215], v4, s[8:11], s50 offen offset:128 nt
    v_lshlrev_b32 v9, 3, v9
    v_lshl_add_u32 v9, v10, 2, v9
    s_lshl_b32 s52, s3, 8
    v_add_u32 v9, s52, v9
    s_mov_b32 s65, 0
    s_waitcnt vmcnt(10)
L_q_9_sequential_p:
    v_xor_b32 v72, s96, v64
    v_xor_b32 v73, s97, v65
    v_xor_b32 v74, s98, v66
    v_xor_b32 v75, s99, v67
    v_xor_b32 v76, s96, v68
    v_xor_b32 v77, s97, v69
    v_xor_b32 v78, s98, v70
    v_xor_b32 v79, s99, v71
    v_or3_b32 v27, v72, v73, v74
    v_or3_b32 v28, v76, v77, v78
    v_or3_b32 v27, v27, v28, v79
    v_or_b32 v27, v27, v75
    v_and_b32 v27, 0x1f, v27
    v_cmp_ne_u32 vcc, 0, v27
    s_cbranch_vccz L_qd_10_sequential_p
    buffer_load_dwordx4 v[64:67], v12, s[36:39], s48 offen sc1
    buffer_load_dwordx4 v[68:71], v12, s[36:39], s49 offen sc1
    s_add_u32 s65, s65, 1
    s_cmp_lt_u32 s65, 262144
    s_waitcnt vmcnt(0)
    s_cbranch_scc1 L_q_9_sequential_p
L_qd_10_sequential_p:
    v_pk_add_f32 v[64:65], v[72:73], v[76:77]
    v_pk_add_f32 v[66:67], v[74:75], v[78:79]
    s_nop 1
    v_permlane32_swap_b32 v64, v66
    v_permlane32_swap_b32 v65, v67
    v_pk_add_f32 v[64:65], v[64:65], v[66:67]
    v_cvt_pk_bf16_f32 v64, v64, v65
    ds_write_b32 v9, v64 offset:2048
    v_mov_b32 v27, 0
    v_mov_b32 v28, -1
    ds_write_b32 v27, v28 offset:7168
    s_waitcnt lgkmcnt(0)
    s_barrier
    s_add_u32 s50, s44, 12587008
    buffer_load_dwordx4 v[216:219], v4, s[8:11], s50 offen offset:512 nt
    buffer_load_dwordx4 v[220:223], v4, s[8:11], s50 offen offset:640 nt
    v_and_b32 v9, 7, v3
    v_lshlrev_b32 v9, 8, v9
    v_lshrrev_b32 v10, 3, v3
    v_lshl_add_u32 v9, v10, 6, v9
    v_lshl_add_u32 v9, v2, 4, v9
    ds_read_b128 v[16:19], v9 offset:2048
    ds_read_b128 v[20:23], v9 offset:2176
    v_mov_b32 v64, 0
    v_mov_b32 v65, 0
    v_mov_b32 v66, 0
    v_mov_b32 v67, 0
    v_mov_b32 v68, 0
    v_mov_b32 v69, 0
    v_mov_b32 v70, 0
    v_mov_b32 v71, 0
    v_mov_b32 v72, 0
    v_mov_b32 v73, 0
    v_mov_b32 v74, 0
    v_mov_b32 v75, 0
    v_mov_b32 v76, 0
    v_mov_b32 v77, 0
    v_mov_b32 v78, 0
    v_mov_b32 v79, 0
    v_mov_b32 v80, 0
    v_mov_b32 v81, 0
    v_mov_b32 v82, 0
    v_mov_b32 v83, 0
    v_mov_b32 v84, 0
    v_mov_b32 v85, 0
    v_mov_b32 v86, 0
    v_mov_b32 v87, 0
    v_mov_b32 v88, 0
    v_mov_b32 v89, 0
    v_mov_b32 v90, 0
    v_mov_b32 v91, 0
    v_mov_b32 v92, 0
    v_mov_b32 v93, 0
    v_mov_b32 v94, 0
    v_mov_b32 v95, 0
    s_bfe_u32 s53, s2, 0x20001
    s_mul_i32 s53, s53, 28
    s_lshr_b32 s52, s2, 3
    s_add_u32 s53, s53, s52
    s_sub_u32 s53, s53, s45
    s_and_b32 s52, s52, 7
    s_cmp_lg_u32 s52, 7
    s_cselect_b32 s56, 1, 0
    s_bitcmp0_b32 s2, 0
    s_cselect_b32 s56, s56, 0
    s_lshl_b32 s52, s3, 8
    s_mul_i32 s46, s3, 917504
    s_lshl_b32 s47, s53, 6
    s_add_u32 s46, s46, s47
    s_lshl_b32 s47, s53, 16
    s_add_u32 s47, s47, s52
    s_add_u32 s54, s53, 128
    s_lshl_b32 s54, s54, 12
    s_lshl_b32 s52, s3, 9
    s_add_u32 s55, s52, 0x300000
    s_add_u32 s54, s54, s55
    s_lshl_b32 s43, s45, 15
    s_add_u32 s43, s43, 0x200020
    s_or_b32 s94, s56, s3
    s_mov_b32 s50, 57344
    v_lshrrev_b32 v7, 2, v1
    v_mul_lo_u32 v7, v7, s50
    v_and_b32 v11, 3, v1
    v_lshl_add_u32 v7, v11, 4, v7
    v_mul_u32_u24 v15, 1152, v2
    v_lshl_add_u32 v15, v11, 5, v15
    s_mul_i32 s52, s3, 144
    v_add_u32 v15, s52, v15
    v_lshrrev_b32 v11, 3, v3
    v_and_b32 v14, 7, v3
    v_mul_u32_u24 v14, 144, v14
    v_lshl_add_u32 v14, v2, 5, v14
    v_lshl_add_u32 v14, v11, 4, v14
    v_lshlrev_b32 v8, 14, v2
    v_lshl_add_u32 v8, v3, 4, v8
    v_lshlrev_b32 v11, 5, v3
    v_lshl_add_u32 v11, v2, 4, v11
    s_bfe_u32 s40, s2, 0x20001
    s_mul_i32 s40, s40, 14
    s_add_u32 s42, s40, 14
    s_add_u32 s40, s40, 4
    s_and_b32 s40, s40, -8
    s_add_u32 s40, s40, 3
    s_lshr_b32 s41, s2, 7
    s_lshl_b32 s41, s41, 3
    s_add_u32 s40, s40, s41
    s_cmp_lt_u32 s40, s42
    s_cselect_b32 s42, 1, 0
    s_bitcmp0_b32 s2, 0
    s_cselect_b32 s42, s42, 0
    s_lshl_b32 s40, s40, 7
    s_bfe_u32 s41, s2, 0x40003
    s_mul_i32 s41, s41, 458752
    s_add_u32 s40, s40, s41
    v_mul_u32_u24 v225, 7168, v1
    s_cmp_eq_u32 s3, 7
    s_cselect_b32 s42, s42, 0
    s_bfe_u32 s41, s2, 0x20003
    s_cmp_eq_u32 s42, 0
    s_cselect_b32 s41, 99, s41
    s_cmp_lg_u32 s41, 0
    s_cbranch_scc1 L_pf_11_sequential_p
    buffer_load_dword v224, v225, s[24:27], s40 offen
L_pf_11_sequential_p:
    s_waitcnt lgkmcnt(0)
    s_waitcnt vmcnt(24)
    v_mfma_f32_16x16x32_bf16 v[32:35], v[96:99], v[16:19], 0
    v_mfma_f32_16x16x32_bf16 v[36:39], v[104:107], v[16:19], 0
    v_mfma_f32_16x16x32_bf16 v[40:43], v[112:115], v[16:19], 0
    v_mfma_f32_16x16x32_bf16 v[44:47], v[120:123], v[16:19], 0
    v_mfma_f32_16x16x32_bf16 v[32:35], v[100:103], v[20:23], v[32:35]
    v_mfma_f32_16x16x32_bf16 v[36:39], v[108:111], v[20:23], v[36:39]
    v_mfma_f32_16x16x32_bf16 v[40:43], v[116:119], v[20:23], v[40:43]
    v_mfma_f32_16x16x32_bf16 v[44:47], v[124:127], v[20:23], v[44:47]
    s_nop 5
    v_permlane32_swap_b32 v32, v36
    v_permlane32_swap_b32 v33, v37
    v_permlane32_swap_b32 v34, v38
    v_permlane32_swap_b32 v35, v39
    v_permlane32_swap_b32 v40, v44
    v_permlane32_swap_b32 v41, v45
    v_permlane32_swap_b32 v42, v46
    v_permlane32_swap_b32 v43, v47
    v_add_f32_dpp v240, v36, v32 row_ror:8 row_mask:0xf bank_mask:0x3
    v_add_f32_dpp v241, v37, v33 row_ror:8 row_mask:0xf bank_mask:0x3
    v_add_f32_dpp v242, v38, v34 row_ror:8 row_mask:0xf bank_mask:0x3
    v_add_f32_dpp v243, v39, v35 row_ror:8 row_mask:0xf bank_mask:0x3
    v_add_f32_dpp v240, v40, v44 row_ror:8 row_mask:0xf bank_mask:0xc
    v_add_f32_dpp v241, v41, v45 row_ror:8 row_mask:0xf bank_mask:0xc
    v_add_f32_dpp v242, v42, v46 row_ror:8 row_mask:0xf bank_mask:0xc
    v_add_f32_dpp v243, v43, v47 row_ror:8 row_mask:0xf bank_mask:0xc
    v_cvt_pk_bf16_f32 v27, v240, v241
    v_cvt_pk_bf16_f32 v28, v242, v243
    v_lshlrev_b32 v240, 16, v27
    v_and_b32 v241, s64, v27
    v_lshlrev_b32 v242, 16, v28
    v_and_b32 v243, s64, v28
    v_mul_f32 v240, s61, v240
    v_mul_f32 v241, s61, v241
    v_mul_f32 v242, s61, v242
    v_mul_f32 v243, s61, v243
    v_cvt_pk_bf16_f32 v27, v240, v241
    v_cvt_pk_bf16_f32 v28, v242, v243
    v_lshlrev_b32 v240, 16, v27
    v_and_b32 v241, s64, v27
    v_lshlrev_b32 v242, 16, v28
    v_and_b32 v243, s64, v28
    v_max3_f32 v24, v240, v241, v242
    v_max_f32 v24, v24, v243
    s_waitcnt vmcnt(16)
    v_mfma_f32_16x16x32_bf16 v[32:35], v[128:131], v[16:19], 0
    v_mfma_f32_16x16x32_bf16 v[36:39], v[136:139], v[16:19], 0
    v_mfma_f32_16x16x32_bf16 v[40:43], v[144:147], v[16:19], 0
    v_mfma_f32_16x16x32_bf16 v[44:47], v[152:155], v[16:19], 0
    v_mfma_f32_16x16x32_bf16 v[32:35], v[132:135], v[20:23], v[32:35]
    v_mfma_f32_16x16x32_bf16 v[36:39], v[140:143], v[20:23], v[36:39]
    v_mfma_f32_16x16x32_bf16 v[40:43], v[148:151], v[20:23], v[40:43]
    v_mfma_f32_16x16x32_bf16 v[44:47], v[156:159], v[20:23], v[44:47]
    s_nop 5
    v_permlane32_swap_b32 v32, v36
    v_permlane32_swap_b32 v33, v37
    v_permlane32_swap_b32 v34, v38
    v_permlane32_swap_b32 v35, v39
    v_permlane32_swap_b32 v40, v44
    v_permlane32_swap_b32 v41, v45
    v_permlane32_swap_b32 v42, v46
    v_permlane32_swap_b32 v43, v47
    v_add_f32_dpp v244, v36, v32 row_ror:8 row_mask:0xf bank_mask:0x3
    v_add_f32_dpp v245, v37, v33 row_ror:8 row_mask:0xf bank_mask:0x3
    v_add_f32_dpp v246, v38, v34 row_ror:8 row_mask:0xf bank_mask:0x3
    v_add_f32_dpp v247, v39, v35 row_ror:8 row_mask:0xf bank_mask:0x3
    v_add_f32_dpp v244, v40, v44 row_ror:8 row_mask:0xf bank_mask:0xc
    v_add_f32_dpp v245, v41, v45 row_ror:8 row_mask:0xf bank_mask:0xc
    v_add_f32_dpp v246, v42, v46 row_ror:8 row_mask:0xf bank_mask:0xc
    v_add_f32_dpp v247, v43, v47 row_ror:8 row_mask:0xf bank_mask:0xc
    v_cvt_pk_bf16_f32 v27, v244, v245
    v_cvt_pk_bf16_f32 v28, v246, v247
    v_lshlrev_b32 v244, 16, v27
    v_and_b32 v245, s64, v27
    v_lshlrev_b32 v246, 16, v28
    v_and_b32 v247, s64, v28
    v_mul_f32 v244, s61, v244
    v_mul_f32 v245, s61, v245
    v_mul_f32 v246, s61, v246
    v_mul_f32 v247, s61, v247
    v_cvt_pk_bf16_f32 v27, v244, v245
    v_cvt_pk_bf16_f32 v28, v246, v247
    v_lshlrev_b32 v244, 16, v27
    v_and_b32 v245, s64, v27
    v_lshlrev_b32 v246, 16, v28
    v_and_b32 v247, s64, v28
    v_max3_f32 v24, v24, v244, v245
    v_max3_f32 v24, v24, v246, v247
    s_waitcnt vmcnt(8)
    v_mfma_f32_16x16x32_bf16 v[32:35], v[160:163], v[16:19], 0
    v_mfma_f32_16x16x32_bf16 v[36:39], v[168:171], v[16:19], 0
    v_mfma_f32_16x16x32_bf16 v[40:43], v[176:179], v[16:19], 0
    v_mfma_f32_16x16x32_bf16 v[44:47], v[184:187], v[16:19], 0
    v_mfma_f32_16x16x32_bf16 v[32:35], v[164:167], v[20:23], v[32:35]
    v_mfma_f32_16x16x32_bf16 v[36:39], v[172:175], v[20:23], v[36:39]
    v_mfma_f32_16x16x32_bf16 v[40:43], v[180:183], v[20:23], v[40:43]
    v_mfma_f32_16x16x32_bf16 v[44:47], v[188:191], v[20:23], v[44:47]
    s_cmp_lg_u32 s41, 1
    s_cbranch_scc1 L_pf_12_sequential_p
    buffer_load_dword v224, v225, s[24:27], s40 offen
L_pf_12_sequential_p:
    s_setprio 2
    s_add_u32 s50, s44, 0
    buffer_load_dwordx4 v[96:99], v6, s[12:15], s50 offen offset:0 nt
    buffer_load_dwordx4 v[100:103], v6, s[12:15], s50 offen offset:1024 nt
    buffer_load_dwordx4 v[104:107], v6, s[12:15], s50 offen offset:2048 nt
    buffer_load_dwordx4 v[108:111], v6, s[12:15], s50 offen offset:3072 nt
    s_add_u32 s50, s44, 4096
    buffer_load_dwordx4 v[112:115], v6, s[12:15], s50 offen offset:0 nt
    buffer_load_dwordx4 v[116:119], v6, s[12:15], s50 offen offset:1024 nt
    buffer_load_dwordx4 v[120:123], v6, s[12:15], s50 offen offset:2048 nt
    buffer_load_dwordx4 v[124:127], v6, s[12:15], s50 offen offset:3072 nt
    v_permlane32_swap_b32 v32, v36
    v_permlane32_swap_b32 v33, v37
    v_permlane32_swap_b32 v34, v38
    v_permlane32_swap_b32 v35, v39
    v_permlane32_swap_b32 v40, v44
    v_permlane32_swap_b32 v41, v45
    v_permlane32_swap_b32 v42, v46
    v_permlane32_swap_b32 v43, v47
    v_add_f32_dpp v248, v36, v32 row_ror:8 row_mask:0xf bank_mask:0x3
    v_add_f32_dpp v249, v37, v33 row_ror:8 row_mask:0xf bank_mask:0x3
    v_add_f32_dpp v250, v38, v34 row_ror:8 row_mask:0xf bank_mask:0x3
    v_add_f32_dpp v251, v39, v35 row_ror:8 row_mask:0xf bank_mask:0x3
    v_add_f32_dpp v248, v40, v44 row_ror:8 row_mask:0xf bank_mask:0xc
    v_add_f32_dpp v249, v41, v45 row_ror:8 row_mask:0xf bank_mask:0xc
    v_add_f32_dpp v250, v42, v46 row_ror:8 row_mask:0xf bank_mask:0xc
    v_add_f32_dpp v251, v43, v47 row_ror:8 row_mask:0xf bank_mask:0xc
    v_cvt_pk_bf16_f32 v27, v248, v249
    v_cvt_pk_bf16_f32 v28, v250, v251
    v_lshlrev_b32 v248, 16, v27
    v_and_b32 v249, s64, v27
    v_lshlrev_b32 v250, 16, v28
    v_and_b32 v251, s64, v28
    v_mul_f32 v248, s61, v248
    v_mul_f32 v249, s61, v249
    v_mul_f32 v250, s61, v250
    v_mul_f32 v251, s61, v251
    v_cvt_pk_bf16_f32 v27, v248, v249
    v_cvt_pk_bf16_f32 v28, v250, v251
    v_lshlrev_b32 v248, 16, v27
    v_and_b32 v249, s64, v27
    v_lshlrev_b32 v250, 16, v28
    v_and_b32 v251, s64, v28
    v_max3_f32 v24, v24, v248, v249
    v_max3_f32 v24, v24, v250, v251
    s_mov_b64 exec, 0
    s_cmp_eq_u32 s3, 1
    s_cbranch_scc1 L_wm_e1_sequential_p
    s_cmp_eq_u32 s3, 2
    s_cbranch_scc1 L_wm_e2_sequential_p
    s_cmp_eq_u32 s3, 3
    s_cbranch_scc1 L_wm_e3_sequential_p
    s_cmp_eq_u32 s3, 4
    s_cbranch_scc1 L_wm_e4_sequential_p
    s_cmp_eq_u32 s3, 5
    s_cbranch_scc1 L_wm_e5_sequential_p
    s_cmp_eq_u32 s3, 6
    s_cbranch_scc1 L_wm_e6_sequential_p
    s_cmp_eq_u32 s3, 7
    s_cbranch_scc1 L_wm_e7_sequential_p
    s_branch L_wm_e0_sequential_p
L_wm_ret_sequential_p:
    s_mov_b64 exec, -1
    s_waitcnt vmcnt(8)
    v_mfma_f32_16x16x32_bf16 v[32:35], v[192:195], v[16:19], 0
    v_mfma_f32_16x16x32_bf16 v[36:39], v[200:203], v[16:19], 0
    v_mfma_f32_16x16x32_bf16 v[40:43], v[208:211], v[16:19], 0
    v_mfma_f32_16x16x32_bf16 v[44:47], v[216:219], v[16:19], 0
    v_mfma_f32_16x16x32_bf16 v[32:35], v[196:199], v[20:23], v[32:35]
    v_mfma_f32_16x16x32_bf16 v[36:39], v[204:207], v[20:23], v[36:39]
    v_mfma_f32_16x16x32_bf16 v[40:43], v[212:215], v[20:23], v[40:43]
    v_mfma_f32_16x16x32_bf16 v[44:47], v[220:223], v[20:23], v[44:47]
    s_nop 5
    v_permlane32_swap_b32 v32, v36
    v_permlane32_swap_b32 v33, v37
    v_permlane32_swap_b32 v34, v38
    v_permlane32_swap_b32 v35, v39
    v_permlane32_swap_b32 v40, v44
    v_permlane32_swap_b32 v41, v45
    v_permlane32_swap_b32 v42, v46
    v_permlane32_swap_b32 v43, v47
    v_add_f32_dpp v252, v36, v32 row_ror:8 row_mask:0xf bank_mask:0x3
    v_add_f32_dpp v253, v37, v33 row_ror:8 row_mask:0xf bank_mask:0x3
    v_add_f32_dpp v254, v38, v34 row_ror:8 row_mask:0xf bank_mask:0x3
    v_add_f32_dpp v255, v39, v35 row_ror:8 row_mask:0xf bank_mask:0x3
    v_add_f32_dpp v252, v40, v44 row_ror:8 row_mask:0xf bank_mask:0xc
    v_add_f32_dpp v253, v41, v45 row_ror:8 row_mask:0xf bank_mask:0xc
    v_add_f32_dpp v254, v42, v46 row_ror:8 row_mask:0xf bank_mask:0xc
    v_add_f32_dpp v255, v43, v47 row_ror:8 row_mask:0xf bank_mask:0xc
    v_cvt_pk_bf16_f32 v27, v252, v253
    v_cvt_pk_bf16_f32 v28, v254, v255
    v_lshlrev_b32 v252, 16, v27
    v_and_b32 v253, s64, v27
    v_lshlrev_b32 v254, 16, v28
    v_and_b32 v255, s64, v28
    v_mul_f32 v252, s61, v252
    v_mul_f32 v253, s61, v253
    v_mul_f32 v254, s61, v254
    v_mul_f32 v255, s61, v255
    v_cvt_pk_bf16_f32 v27, v252, v253
    v_cvt_pk_bf16_f32 v28, v254, v255
    v_lshlrev_b32 v252, 16, v27
    v_and_b32 v253, s64, v27
    v_lshlrev_b32 v254, 16, v28
    v_and_b32 v255, s64, v28
    v_max3_f32 v24, v24, v252, v253
    v_max3_f32 v24, v24, v254, v255
    s_nop 1
    v_max_f32_dpp v24, v24, v24 row_ror:8 row_mask:0xf bank_mask:0xf
    v_mov_b32 v28, v24
    s_nop 1
    v_permlane16_swap_b32 v24, v28
    v_max_f32 v24, v24, v28
    v_mov_b32 v28, v24
    s_nop 1
    v_permlane32_swap_b32 v24, v28
    v_max_f32 v24, v24, v28
    v_and_b32 v13, 7, v3
    v_lshlrev_b32 v13, 5, v13
    s_lshl_b32 s48, s3, 2
    v_add_u32 v12, s48, v13
    s_mov_b64 exec, 0xff
    ds_write_b32 v12, v24 offset:4096
    s_mov_b64 exec, -1
    s_waitcnt lgkmcnt(0)
    s_barrier
    ds_read_b128 v[32:35], v13 offset:4096
    ds_read_b128 v[36:39], v13 offset:4112
    s_cmp_lg_u32 s41, 2
    s_cbranch_scc1 L_pf_13_sequential_p
    buffer_load_dword v224, v225, s[24:27], s40 offen
L_pf_13_sequential_p:
    s_setprio 2
    s_add_u32 s50, s44, 4194304
    buffer_load_dwordx4 v[128:131], v6, s[12:15], s50 offen offset:0 nt
    buffer_load_dwordx4 v[132:135], v6, s[12:15], s50 offen offset:1024 nt
    buffer_load_dwordx4 v[136:139], v6, s[12:15], s50 offen offset:2048 nt
    buffer_load_dwordx4 v[140:143], v6, s[12:15], s50 offen offset:3072 nt
    s_add_u32 s50, s44, 4198400
    buffer_load_dwordx4 v[144:147], v6, s[12:15], s50 offen offset:0 nt
    buffer_load_dwordx4 v[148:151], v6, s[12:15], s50 offen offset:1024 nt
    buffer_load_dwordx4 v[152:155], v6, s[12:15], s50 offen offset:2048 nt
    buffer_load_dwordx4 v[156:159], v6, s[12:15], s50 offen offset:3072 nt
    s_waitcnt lgkmcnt(0)
    v_max3_f32 v24, v32, v33, v34
    v_max3_f32 v28, v35, v36, v37
    v_max3_f32 v24, v24, v38, v39
    v_max_f32 v24, v24, v28
    v_mul_f32 v26, s60, v24
    v_fma_f32 v240, v240, s60, -v26
    v_fma_f32 v241, v241, s60, -v26
    v_fma_f32 v242, v242, s60, -v26
    v_fma_f32 v243, v243, s60, -v26
    v_fma_f32 v244, v244, s60, -v26
    v_fma_f32 v245, v245, s60, -v26
    v_fma_f32 v246, v246, s60, -v26
    v_fma_f32 v247, v247, s60, -v26
    v_fma_f32 v248, v248, s60, -v26
    v_fma_f32 v249, v249, s60, -v26
    v_fma_f32 v250, v250, s60, -v26
    v_fma_f32 v251, v251, s60, -v26
    v_fma_f32 v252, v252, s60, -v26
    v_fma_f32 v253, v253, s60, -v26
    v_fma_f32 v254, v254, s60, -v26
    v_fma_f32 v255, v255, s60, -v26
    v_exp_f32 v240, v240
    v_exp_f32 v241, v241
    v_exp_f32 v242, v242
    v_exp_f32 v243, v243
    v_exp_f32 v244, v244
    v_exp_f32 v245, v245
    v_exp_f32 v246, v246
    v_exp_f32 v247, v247
    v_exp_f32 v248, v248
    v_exp_f32 v249, v249
    v_exp_f32 v250, v250
    v_exp_f32 v251, v251
    v_exp_f32 v252, v252
    v_exp_f32 v253, v253
    v_exp_f32 v254, v254
    v_exp_f32 v255, v255
    v_add_f32 v32, v240, v241
    v_add_f32 v33, v242, v243
    v_add_f32 v34, v244, v245
    v_add_f32 v35, v246, v247
    v_add_f32 v36, v248, v249
    v_add_f32 v37, v250, v251
    v_add_f32 v38, v252, v253
    v_add_f32 v39, v254, v255
    v_cvt_pk_bf16_f32 v240, v240, v241
    v_cvt_pk_bf16_f32 v241, v242, v243
    v_cvt_pk_bf16_f32 v244, v244, v245
    v_cvt_pk_bf16_f32 v245, v246, v247
    v_cvt_pk_bf16_f32 v248, v248, v249
    v_cvt_pk_bf16_f32 v249, v250, v251
    v_cvt_pk_bf16_f32 v252, v252, v253
    v_cvt_pk_bf16_f32 v253, v254, v255
    v_add_f32 v32, v32, v36
    v_add_f32 v33, v33, v37
    v_add_f32 v34, v34, v38
    v_add_f32 v35, v35, v39
    v_add_f32 v32, v32, v34
    v_add_f32 v33, v33, v35
    v_add_f32 v32, v32, v33
    v_mov_b32_dpp v242, v240 row_ror:8 row_mask:0xf bank_mask:0xf
    v_mov_b32_dpp v243, v241 row_ror:8 row_mask:0xf bank_mask:0xf
    v_mov_b32_dpp v246, v244 row_ror:8 row_mask:0xf bank_mask:0xf
    v_mov_b32_dpp v247, v245 row_ror:8 row_mask:0xf bank_mask:0xf
    v_mov_b32_dpp v250, v248 row_ror:8 row_mask:0xf bank_mask:0xf
    v_mov_b32_dpp v251, v249 row_ror:8 row_mask:0xf bank_mask:0xf
    v_mov_b32_dpp v254, v252 row_ror:8 row_mask:0xf bank_mask:0xf
    v_mov_b32_dpp v255, v253 row_ror:8 row_mask:0xf bank_mask:0xf
    v_add_f32_dpp v25, v32, v32 row_ror:8 row_mask:0xf bank_mask:0xf
    v_mov_b32 v28, v25
    s_nop 1
    v_permlane16_swap_b32 v25, v28
    v_add_f32 v25, v25, v28
    v_mov_b32 v28, v25
    s_nop 1
    v_permlane32_swap_b32 v25, v28
    v_add_f32 v25, v25, v28
    s_mov_b64 exec, 0xff
    ds_write_b32 v12, v25 offset:4352
    s_mov_b64 exec, -1
    v_and_b32 v12, 7, v3
    v_mul_u32_u24 v12, 528, v12
    v_lshl_add_u32 v12, v2, 7, v12
    v_lshrrev_b32 v13, 3, v3
    v_lshl_add_u32 v12, v13, 6, v12
    s_mul_i32 s48, s3, 4224
    v_add_u32 v12, s48, v12
    v_and_b32 v13, 31, v1
    v_lshlrev_b32 v13, 4, v13
    v_lshrrev_b32 v9, 5, v1
    v_mul_u32_u24 v9, 16896, v9
    v_add_u32 v13, v13, v9
    s_mul_i32 s48, s3, 528
    v_add_u32 v13, s48, v13
    v_lshrrev_b32 v10, 3, v1
    v_lshlrev_b32 v10, 13, v10
    v_and_b32 v9, 7, v1
    v_lshl_add_u32 v10, v9, 4, v10
    s_lshl_b32 s48, s3, 5
    v_mov_b32 v9, s48
    s_lshl_b32 s57, s45, 3
    s_add_u32 s57, s57, s3
    s_lshl_b32 s57, s57, 15
    s_and_b32 s50, s2, 63
    s_lshl_b32 s50, s50, 7
    s_add_u32 s57, s57, s50
    s_add_u32 s57, s57, 0x100000
    s_lshl_b32 s58, s2, 9
    s_lshl_b32 s50, s3, 6
    s_add_u32 s58, s58, s50
    s_add_u32 s58, s58, 0x200000
    v_readlane_b32 s95, v24, s3
    s_nop 1
    v_mov_b32 v232, s95
    v_mov_b32 v29, 0
    v_mov_b32 v234, s68
    v_mov_b32 v235, s69
    s_mov_b32 s95, 0xffffffe0
    v_mov_b32 v228, s96
    v_mov_b32 v229, s97
    v_mov_b32 v230, s98
    v_mov_b32 v231, s99
    s_cmp_lg_u32 s41, 3
    s_cbranch_scc1 L_pf_14_sequential_p
    buffer_load_dword v224, v225, s[24:27], s40 offen
L_pf_14_sequential_p:
    s_setprio 1
    s_add_u32 s50, s44, 8388608
    buffer_load_dwordx4 v[160:163], v6, s[12:15], s50 offen offset:0 nt
    buffer_load_dwordx4 v[164:167], v6, s[12:15], s50 offen offset:1024 nt
    buffer_load_dwordx4 v[168:171], v6, s[12:15], s50 offen offset:2048 nt
    buffer_load_dwordx4 v[172:175], v6, s[12:15], s50 offen offset:3072 nt
    s_add_u32 s50, s44, 8392704
    buffer_load_dwordx4 v[176:179], v6, s[12:15], s50 offen offset:0 nt
    buffer_load_dwordx4 v[180:183], v6, s[12:15], s50 offen offset:1024 nt
    buffer_load_dwordx4 v[184:187], v6, s[12:15], s50 offen offset:2048 nt
    buffer_load_dwordx4 v[188:191], v6, s[12:15], s50 offen offset:3072 nt
    s_waitcnt vmcnt(16)
    v_perm_b32 v56, v100, v96, s62
    v_perm_b32 v57, v108, v104, s62
    v_perm_b32 v58, v116, v112, s62
    v_perm_b32 v59, v124, v120, s62
    v_perm_b32 v60, v100, v96, s63
    v_perm_b32 v61, v108, v104, s63
    v_perm_b32 v62, v116, v112, s63
    v_perm_b32 v63, v124, v120, s63
    v_mfma_f32_16x16x32_bf16 v[64:67], v[56:59], v[240:243], v[64:67]
    v_perm_b32 v56, v101, v97, s62
    v_perm_b32 v57, v109, v105, s62
    v_perm_b32 v58, v117, v113, s62
    v_perm_b32 v59, v125, v121, s62
    v_mfma_f32_16x16x32_bf16 v[68:71], v[60:63], v[240:243], v[68:71]
    v_perm_b32 v60, v101, v97, s63
    v_perm_b32 v61, v109, v105, s63
    v_perm_b32 v62, v117, v113, s63
    v_perm_b32 v63, v125, v121, s63
    v_mfma_f32_16x16x32_bf16 v[72:75], v[56:59], v[240:243], v[72:75]
    v_perm_b32 v56, v102, v98, s62
    v_perm_b32 v57, v110, v106, s62
    v_perm_b32 v58, v118, v114, s62
    v_perm_b32 v59, v126, v122, s62
    v_mfma_f32_16x16x32_bf16 v[76:79], v[60:63], v[240:243], v[76:79]
    v_perm_b32 v60, v102, v98, s63
    v_perm_b32 v61, v110, v106, s63
    v_perm_b32 v62, v118, v114, s63
    v_perm_b32 v63, v126, v122, s63
    v_mfma_f32_16x16x32_bf16 v[80:83], v[56:59], v[240:243], v[80:83]
    v_perm_b32 v56, v103, v99, s62
    v_perm_b32 v57, v111, v107, s62
    v_perm_b32 v58, v119, v115, s62
    v_perm_b32 v59, v127, v123, s62
    v_mfma_f32_16x16x32_bf16 v[84:87], v[60:63], v[240:243], v[84:87]
    v_perm_b32 v60, v103, v99, s63
    v_perm_b32 v61, v111, v107, s63
    v_perm_b32 v62, v119, v115, s63
    v_perm_b32 v63, v127, v123, s63
    v_mfma_f32_16x16x32_bf16 v[88:91], v[56:59], v[240:243], v[88:91]
    s_nop 0
    v_mfma_f32_16x16x32_bf16 v[92:95], v[60:63], v[240:243], v[92:95]
    s_setprio 0
    s_add_u32 s50, s44, 12582912
    buffer_load_dwordx4 v[192:195], v6, s[12:15], s50 offen offset:0 nt
    buffer_load_dwordx4 v[196:199], v6, s[12:15], s50 offen offset:1024 nt
    buffer_load_dwordx4 v[200:203], v6, s[12:15], s50 offen offset:2048 nt
    buffer_load_dwordx4 v[204:207], v6, s[12:15], s50 offen offset:3072 nt
    s_add_u32 s50, s44, 12587008
    buffer_load_dwordx4 v[208:211], v6, s[12:15], s50 offen offset:0 nt
    buffer_load_dwordx4 v[212:215], v6, s[12:15], s50 offen offset:1024 nt
    buffer_load_dwordx4 v[216:219], v6, s[12:15], s50 offen offset:2048 nt
    buffer_load_dwordx4 v[220:223], v6, s[12:15], s50 offen offset:3072 nt
    s_cmp_lg_u32 s94, 0
    s_cbranch_scc1 L_tk_15_sequential_p
    s_mov_b64 exec, 1
    v_mov_b32 v28, 1
    buffer_atomic_add v28, v29, s[36:39], s43 offen sc0 sc1
    s_mov_b64 exec, -1
L_tk_15_sequential_p:
    s_waitcnt vmcnt(16)
    v_perm_b32 v56, v132, v128, s62
    v_perm_b32 v57, v140, v136, s62
    v_perm_b32 v58, v148, v144, s62
    v_perm_b32 v59, v156, v152, s62
    v_perm_b32 v60, v132, v128, s63
    v_perm_b32 v61, v140, v136, s63
    v_perm_b32 v62, v148, v144, s63
    v_perm_b32 v63, v156, v152, s63
    v_mfma_f32_16x16x32_bf16 v[64:67], v[56:59], v[244:247], v[64:67]
    v_perm_b32 v56, v133, v129, s62
    v_perm_b32 v57, v141, v137, s62
    v_perm_b32 v58, v149, v145, s62
    v_perm_b32 v59, v157, v153, s62
    v_mfma_f32_16x16x32_bf16 v[68:71], v[60:63], v[244:247], v[68:71]
    v_perm_b32 v60, v133, v129, s63
    v_perm_b32 v61, v141, v137, s63
    v_perm_b32 v62, v149, v145, s63
    v_perm_b32 v63, v157, v153, s63
    v_mfma_f32_16x16x32_bf16 v[72:75], v[56:59], v[244:247], v[72:75]
    v_perm_b32 v56, v134, v130, s62
    v_perm_b32 v57, v142, v138, s62
    v_perm_b32 v58, v150, v146, s62
    v_perm_b32 v59, v158, v154, s62
    v_mfma_f32_16x16x32_bf16 v[76:79], v[60:63], v[244:247], v[76:79]
    v_perm_b32 v60, v134, v130, s63
    v_perm_b32 v61, v142, v138, s63
    v_perm_b32 v62, v150, v146, s63
    v_perm_b32 v63, v158, v154, s63
    v_mfma_f32_16x16x32_bf16 v[80:83], v[56:59], v[244:247], v[80:83]
    v_perm_b32 v56, v135, v131, s62
    v_perm_b32 v57, v143, v139, s62
    v_perm_b32 v58, v151, v147, s62
    v_perm_b32 v59, v159, v155, s62
    v_mfma_f32_16x16x32_bf16 v[84:87], v[60:63], v[244:247], v[84:87]
    v_perm_b32 v60, v135, v131, s63
    v_perm_b32 v61, v143, v139, s63
    v_perm_b32 v62, v151, v147, s63
    v_perm_b32 v63, v159, v155, s63
    v_mfma_f32_16x16x32_bf16 v[88:91], v[56:59], v[244:247], v[88:91]
    s_nop 0
    v_mfma_f32_16x16x32_bf16 v[92:95], v[60:63], v[244:247], v[92:95]
    s_waitcnt vmcnt(8)
    v_perm_b32 v56, v164, v160, s62
    v_perm_b32 v57, v172, v168, s62
    v_perm_b32 v58, v180, v176, s62
    v_perm_b32 v59, v188, v184, s62
    v_perm_b32 v60, v164, v160, s63
    v_perm_b32 v61, v172, v168, s63
    v_perm_b32 v62, v180, v176, s63
    v_perm_b32 v63, v188, v184, s63
    v_mfma_f32_16x16x32_bf16 v[64:67], v[56:59], v[248:251], v[64:67]
    v_perm_b32 v56, v165, v161, s62
    v_perm_b32 v57, v173, v169, s62
    v_perm_b32 v58, v181, v177, s62
    v_perm_b32 v59, v189, v185, s62
    v_mfma_f32_16x16x32_bf16 v[68:71], v[60:63], v[248:251], v[68:71]
    v_perm_b32 v60, v165, v161, s63
    v_perm_b32 v61, v173, v169, s63
    v_perm_b32 v62, v181, v177, s63
    v_perm_b32 v63, v189, v185, s63
    v_mfma_f32_16x16x32_bf16 v[72:75], v[56:59], v[248:251], v[72:75]
    v_perm_b32 v56, v166, v162, s62
    v_perm_b32 v57, v174, v170, s62
    v_perm_b32 v58, v182, v178, s62
    v_perm_b32 v59, v190, v186, s62
    v_mfma_f32_16x16x32_bf16 v[76:79], v[60:63], v[248:251], v[76:79]
    v_perm_b32 v60, v166, v162, s63
    v_perm_b32 v61, v174, v170, s63
    v_perm_b32 v62, v182, v178, s63
    v_perm_b32 v63, v190, v186, s63
    v_mfma_f32_16x16x32_bf16 v[80:83], v[56:59], v[248:251], v[80:83]
    v_perm_b32 v56, v167, v163, s62
    v_perm_b32 v57, v175, v171, s62
    v_perm_b32 v58, v183, v179, s62
    v_perm_b32 v59, v191, v187, s62
    v_mfma_f32_16x16x32_bf16 v[84:87], v[60:63], v[248:251], v[84:87]
    v_perm_b32 v60, v167, v163, s63
    v_perm_b32 v61, v175, v171, s63
    v_perm_b32 v62, v183, v179, s63
    v_perm_b32 v63, v191, v187, s63
    v_mfma_f32_16x16x32_bf16 v[88:91], v[56:59], v[248:251], v[88:91]
    s_nop 0
    v_mfma_f32_16x16x32_bf16 v[92:95], v[60:63], v[248:251], v[92:95]
    s_waitcnt vmcnt(0)
    s_cmp_lg_u32 s94, 0
    s_cbranch_scc1 L_tk_16_sequential_p
    s_mov_b64 exec, 1
    v_add_u32 v28, 1, v28
    ds_write_b32 v29, v28 offset:7168
    s_mov_b64 exec, -1
L_tk_16_sequential_p:
    v_perm_b32 v56, v196, v192, s62
    v_perm_b32 v57, v204, v200, s62
    v_perm_b32 v58, v212, v208, s62
    v_perm_b32 v59, v220, v216, s62
    v_perm_b32 v60, v196, v192, s63
    v_perm_b32 v61, v204, v200, s63
    v_perm_b32 v62, v212, v208, s63
    v_perm_b32 v63, v220, v216, s63
    v_mfma_f32_16x16x32_bf16 v[64:67], v[56:59], v[252:255], v[64:67]
    v_perm_b32 v56, v197, v193, s62
    v_perm_b32 v57, v205, v201, s62
    v_perm_b32 v58, v213, v209, s62
    v_perm_b32 v59, v221, v217, s62
    v_mfma_f32_16x16x32_bf16 v[68:71], v[60:63], v[252:255], v[68:71]
    v_perm_b32 v60, v197, v193, s63
    v_perm_b32 v61, v205, v201, s63
    v_perm_b32 v62, v213, v209, s63
    v_perm_b32 v63, v221, v217, s63
    v_mfma_f32_16x16x32_bf16 v[72:75], v[56:59], v[252:255], v[72:75]
    v_perm_b32 v56, v198, v194, s62
    v_perm_b32 v57, v206, v202, s62
    v_perm_b32 v58, v214, v210, s62
    v_perm_b32 v59, v222, v218, s62
    v_mfma_f32_16x16x32_bf16 v[76:79], v[60:63], v[252:255], v[76:79]
    v_perm_b32 v60, v198, v194, s63
    v_perm_b32 v61, v206, v202, s63
    v_perm_b32 v62, v214, v210, s63
    v_perm_b32 v63, v222, v218, s63
    v_mfma_f32_16x16x32_bf16 v[80:83], v[56:59], v[252:255], v[80:83]
    v_perm_b32 v56, v199, v195, s62
    v_perm_b32 v57, v207, v203, s62
    v_perm_b32 v58, v215, v211, s62
    v_perm_b32 v59, v223, v219, s62
    v_mfma_f32_16x16x32_bf16 v[84:87], v[60:63], v[252:255], v[84:87]
    v_perm_b32 v60, v199, v195, s63
    v_perm_b32 v61, v207, v203, s63
    v_perm_b32 v62, v215, v211, s63
    v_perm_b32 v63, v223, v219, s63
    v_mfma_f32_16x16x32_bf16 v[88:91], v[56:59], v[252:255], v[88:91]
    s_nop 0
    v_mfma_f32_16x16x32_bf16 v[92:95], v[60:63], v[252:255], v[92:95]
    s_setprio 0
L_wm_e0_sequential_p:
L_wm_0_sequential_p:
    s_cbranch_execz L_wm_1_sequential_p
    v_mov_b32_dpp v64, v80 row_ror:8 row_mask:0xf bank_mask:0xc
    v_mov_b32_dpp v65, v81 row_ror:8 row_mask:0xf bank_mask:0xc
    v_mov_b32_dpp v66, v82 row_ror:8 row_mask:0xf bank_mask:0xc
    v_mov_b32_dpp v67, v83 row_ror:8 row_mask:0xf bank_mask:0xc
    ds_write_b128 v12, v[64:67] offset:8192
    v_mov_b32_dpp v68, v84 row_ror:8 row_mask:0xf bank_mask:0xc
    v_mov_b32_dpp v69, v85 row_ror:8 row_mask:0xf bank_mask:0xc
L_wm_1_sequential_p:
    s_cbranch_execz L_wm_2_sequential_p
    v_mov_b32_dpp v70, v86 row_ror:8 row_mask:0xf bank_mask:0xc
    v_mov_b32_dpp v71, v87 row_ror:8 row_mask:0xf bank_mask:0xc
    ds_write_b128 v12, v[68:71] offset:8208
    v_mov_b32_dpp v72, v88 row_ror:8 row_mask:0xf bank_mask:0xc
    v_mov_b32_dpp v73, v89 row_ror:8 row_mask:0xf bank_mask:0xc
    v_mov_b32_dpp v74, v90 row_ror:8 row_mask:0xf bank_mask:0xc
    v_mov_b32_dpp v75, v91 row_ror:8 row_mask:0xf bank_mask:0xc
    ds_write_b128 v12, v[72:75] offset:8224
    v_mov_b32_dpp v76, v92 row_ror:8 row_mask:0xf bank_mask:0xc
    v_mov_b32_dpp v77, v93 row_ror:8 row_mask:0xf bank_mask:0xc
    v_mov_b32_dpp v78, v94 row_ror:8 row_mask:0xf bank_mask:0xc
    v_mov_b32_dpp v79, v95 row_ror:8 row_mask:0xf bank_mask:0xc
    ds_write_b128 v12, v[76:79] offset:8240
    s_waitcnt lgkmcnt(0)
    s_barrier
    ds_read_b128 v[64:67], v13 offset:8192
    ds_read_b128 v[68:71], v13 offset:12416
L_wm_2_sequential_p:
    s_cbranch_execz L_wm_3_sequential_p
    ds_read_b128 v[72:75], v13 offset:16640
    ds_read_b128 v[76:79], v13 offset:20864
    ds_read_b128 v[32:35], v9 offset:4352
    ds_read_b128 v[36:39], v9 offset:4368
    ds_read_b32 v28, v29 offset:7168
    s_waitcnt lgkmcnt(5)
    v_pk_add_f32 v[64:65], v[64:65], v[68:69]
    v_pk_add_f32 v[66:67], v[66:67], v[70:71]
    s_waitcnt lgkmcnt(3)
    v_pk_add_f32 v[72:73], v[72:73], v[76:77]
    v_pk_add_f32 v[74:75], v[74:75], v[78:79]
    v_pk_add_f32 v[48:49], v[64:65], v[72:73]
    v_pk_add_f32 v[50:51], v[66:67], v[74:75]
    v_pk_add_f32 v[64:65], v[64:65], v[72:73]
    v_pk_add_f32 v[66:67], v[66:67], v[74:75]
    s_nop 0
    v_permlane32_swap_b32 v48, v64
L_wm_3_sequential_p:
    s_cbranch_execz L_wm_4_sequential_p
    v_permlane32_swap_b32 v49, v65
    v_permlane32_swap_b32 v50, v66
    v_permlane32_swap_b32 v51, v67
    v_pk_add_f32 v[48:49], v[48:49], v[64:65]
    v_pk_add_f32 v[50:51], v[50:51], v[66:67]
    v_and_or_b32 v48, v48, s95, v228
    v_and_or_b32 v49, v49, s95, v229
    v_and_or_b32 v50, v50, s95, v230
    v_and_or_b32 v51, v51, s95, v231
    s_mov_b32 exec_hi, 0
    buffer_store_dwordx4 v[48:51], v10, s[36:39], s57 offen sc1
    s_mov_b64 exec, 1
    s_waitcnt lgkmcnt(0)
    v_pk_add_f32 v[32:33], v[32:33], v[36:37]
    v_pk_add_f32 v[34:35], v[34:35], v[38:39]
    v_pk_add_f32 v[32:33], v[32:33], v[34:35]
    v_add_f32 v233, v32, v33
    buffer_store_dwordx4 v[232:235], v29, s[36:39], s58 offen sc1
    s_mov_b64 exec, -1
    s_cmp_lg_u32 s56, 0
L_wm_4_sequential_p:
    s_cbranch_execz L_wm_5_sequential_p
    s_cbranch_scc1 L_ffn_17_sequential_p
    v_readfirstlane_b32 s41, v28
    s_cmp_ge_u32 s41, 32
    s_cbranch_scc1 L_fin_18_sequential_p
    s_barrier
    s_lshl_b32 s40, s45, 5
    s_add_u32 s40, s40, s41
    s_lshl_b32 s51, s40, 16
    s_lshl_b32 s52, s3, 8
    s_add_u32 s51, s51, s52
    buffer_load_dwordx4 v[128:131], v8, s[20:23], s51 offen offset:0 nt
    buffer_load_dwordx4 v[132:135], v8, s[20:23], s51 offen offset:2048 nt
    s_add_u32 s51, s51, 4096
    buffer_load_dwordx4 v[136:139], v8, s[20:23], s51 offen offset:0 nt
    buffer_load_dwordx4 v[140:143], v8, s[20:23], s51 offen offset:2048 nt
    s_add_u32 s51, s51, 4096
    buffer_load_dwordx4 v[144:147], v8, s[20:23], s51 offen offset:0 nt
    buffer_load_dwordx4 v[148:151], v8, s[20:23], s51 offen offset:2048 nt
    s_add_u32 s51, s51, 4096
    buffer_load_dwordx4 v[152:155], v8, s[20:23], s51 offen offset:0 nt
    buffer_load_dwordx4 v[156:159], v8, s[20:23], s51 offen offset:2048 nt
L_wm_5_sequential_p:
    s_cbranch_execz L_wm_ret_sequential_p
    s_lshl_b32 s54, s40, 12
    s_add_u32 s54, s54, s55
    v_lshlrev_b32 v12, 4, v2
    s_cmp_eq_u32 s3, 0
    s_cbranch_scc1 L_s2w_22_sequential_p
    s_waitcnt vmcnt(0)
    v_perm_b32 v96, v132, v128, s62
    v_perm_b32 v97, v140, v136, s62
    v_perm_b32 v98, v148, v144, s62
    v_perm_b32 v99, v156, v152, s62
    v_perm_b32 v100, v132, v128, s63
    v_perm_b32 v101, v140, v136, s63
    v_perm_b32 v102, v148, v144, s63
    v_perm_b32 v103, v156, v152, s63
    v_perm_b32 v104, v133, v129, s62
    v_perm_b32 v105, v141, v137, s62
    v_perm_b32 v106, v149, v145, s62
    v_perm_b32 v107, v157, v153, s62
L_wm_e1_sequential_p:
L_wm_6_sequential_p:
    s_cbranch_execz L_wm_7_sequential_p
    v_perm_b32 v108, v133, v129, s63
    v_perm_b32 v109, v141, v137, s63
    v_perm_b32 v110, v149, v145, s63
    v_perm_b32 v111, v157, v153, s63
    v_perm_b32 v112, v134, v130, s62
    v_perm_b32 v113, v142, v138, s62
    v_perm_b32 v114, v150, v146, s62
    v_perm_b32 v115, v158, v154, s62
    v_perm_b32 v116, v134, v130, s63
    v_perm_b32 v117, v142, v138, s63
    v_perm_b32 v118, v150, v146, s63
    v_perm_b32 v119, v158, v154, s63
    v_perm_b32 v120, v135, v131, s62
    v_perm_b32 v121, v143, v139, s62
    v_perm_b32 v122, v151, v147, s62
    v_perm_b32 v123, v159, v155, s62
L_wm_7_sequential_p:
    s_cbranch_execz L_wm_8_sequential_p
    v_perm_b32 v124, v135, v131, s63
    v_perm_b32 v125, v143, v139, s63
    v_perm_b32 v126, v151, v147, s63
    v_perm_b32 v127, v159, v155, s63
    s_branch L_s2j_23_sequential_p
L_s2w_22_sequential_p:
    v_lshrrev_b32 v9, 3, v1
    v_lshlrev_b32 v9, 10, v9
    v_and_b32 v13, 7, v1
    v_lshlrev_b32 v13, 4, v13
    v_add_u32 v9, v9, v13
    v_lshlrev_b32 v10, 9, v1
    v_lshrrev_b32 v13, 3, v13
    v_add_u32 v13, v13, v12
    s_lshl_b32 s48, s40, 13
    s_add_u32 s48, s48, 0x100000
    s_bfe_u32 s50, s40, 0x30002
    s_lshl_b32 s49, s45, 15
    s_lshl_b32 s50, s50, 6
    s_add_u32 s49, s49, s50
    s_add_u32 s49, s49, 0x200000
    s_mov_b32 s65, 0
    buffer_load_dwordx4 v[192:195], v10, s[36:39], s49 offen sc1
L_wm_8_sequential_p:
    s_cbranch_execz L_wm_9_sequential_p
    buffer_load_dwordx4 v[160:163], v9, s[36:39], s48 offen offset:0 sc1
    buffer_load_dwordx4 v[164:167], v9, s[36:39], s48 offen offset:128 sc1
    buffer_load_dwordx4 v[168:171], v9, s[36:39], s48 offen offset:256 sc1
    buffer_load_dwordx4 v[172:175], v9, s[36:39], s48 offen offset:384 sc1
    buffer_load_dwordx4 v[176:179], v9, s[36:39], s48 offen offset:512 sc1
    buffer_load_dwordx4 v[180:183], v9, s[36:39], s48 offen offset:640 sc1
    buffer_load_dwordx4 v[184:187], v9, s[36:39], s48 offen offset:768 sc1
    buffer_load_dwordx4 v[188:191], v9, s[36:39], s48 offen offset:896 sc1
    s_waitcnt vmcnt(9)
    v_perm_b32 v96, v132, v128, s62
    v_perm_b32 v97, v140, v136, s62
    v_perm_b32 v98, v148, v144, s62
    v_perm_b32 v99, v156, v152, s62
    v_perm_b32 v100, v132, v128, s63
    v_perm_b32 v101, v140, v136, s63
    v_perm_b32 v102, v148, v144, s63
L_wm_9_sequential_p:
    s_cbranch_execz L_wm_10_sequential_p
    v_perm_b32 v103, v156, v152, s63
    v_perm_b32 v104, v133, v129, s62
    v_perm_b32 v105, v141, v137, s62
    v_perm_b32 v106, v149, v145, s62
    v_perm_b32 v107, v157, v153, s62
    v_perm_b32 v108, v133, v129, s63
    v_perm_b32 v109, v141, v137, s63
    v_perm_b32 v110, v149, v145, s63
    v_perm_b32 v111, v157, v153, s63
    v_perm_b32 v112, v134, v130, s62
    v_perm_b32 v113, v142, v138, s62
    v_perm_b32 v114, v150, v146, s62
    v_perm_b32 v115, v158, v154, s62
    v_perm_b32 v116, v134, v130, s63
    v_perm_b32 v117, v142, v138, s63
    v_perm_b32 v118, v150, v146, s63
L_wm_10_sequential_p:
    s_cbranch_execz L_wm_11_sequential_p
    v_perm_b32 v119, v158, v154, s63
    v_perm_b32 v120, v135, v131, s62
    v_perm_b32 v121, v143, v139, s62
    v_perm_b32 v122, v151, v147, s62
    v_perm_b32 v123, v159, v155, s62
    v_perm_b32 v124, v135, v131, s63
    v_perm_b32 v125, v143, v139, s63
    v_perm_b32 v126, v151, v147, s63
    v_perm_b32 v127, v159, v155, s63
    s_branch L_pw_25_sequential_p
L_poll_24_sequential_p:
    buffer_load_dwordx4 v[192:195], v10, s[36:39], s49 offen sc1
    buffer_load_dwordx4 v[160:163], v9, s[36:39], s48 offen offset:0 sc1
    buffer_load_dwordx4 v[164:167], v9, s[36:39], s48 offen offset:128 sc1
    buffer_load_dwordx4 v[168:171], v9, s[36:39], s48 offen offset:256 sc1
    buffer_load_dwordx4 v[172:175], v9, s[36:39], s48 offen offset:384 sc1
    buffer_load_dwordx4 v[176:179], v9, s[36:39], s48 offen offset:512 sc1
L_wm_11_sequential_p:
    s_cbranch_execz L_wm_ret_sequential_p
    buffer_load_dwordx4 v[180:183], v9, s[36:39], s48 offen offset:640 sc1
    buffer_load_dwordx4 v[184:187], v9, s[36:39], s48 offen offset:768 sc1
    buffer_load_dwordx4 v[188:191], v9, s[36:39], s48 offen offset:896 sc1
    s_add_u32 s65, s65, 1
    s_cmp_ge_u32 s65, 262144
    s_cbranch_scc1 L_pto_26_sequential_p
L_pw_25_sequential_p:
    s_waitcnt vmcnt(0)
    v_cmp_ne_u64 s[42:43], s[68:69], v[194:195]
    v_xor_b32 v160, s96, v160
    v_xor_b32 v161, s97, v161
    v_xor_b32 v162, s98, v162
    v_xor_b32 v163, s99, v163
    v_xor_b32 v164, s96, v164
    v_xor_b32 v165, s97, v165
    v_xor_b32 v166, s98, v166
    v_xor_b32 v167, s99, v167
    v_xor_b32 v168, s96, v168
    v_xor_b32 v169, s97, v169
    v_xor_b32 v170, s98, v170
    v_xor_b32 v171, s99, v171
    v_xor_b32 v172, s96, v172
    v_xor_b32 v173, s97, v173
    v_xor_b32 v174, s98, v174
    v_xor_b32 v175, s99, v175
    v_xor_b32 v176, s96, v176
L_wm_e2_sequential_p:
L_wm_12_sequential_p:
    s_cbranch_execz L_wm_13_sequential_p
    v_xor_b32 v177, s97, v177
    v_xor_b32 v178, s98, v178
    v_xor_b32 v179, s99, v179
    v_xor_b32 v180, s96, v180
    v_xor_b32 v181, s97, v181
    v_xor_b32 v182, s98, v182
    v_xor_b32 v183, s99, v183
    v_xor_b32 v184, s96, v184
    v_xor_b32 v185, s97, v185
    v_xor_b32 v186, s98, v186
    v_xor_b32 v187, s99, v187
    v_xor_b32 v188, s96, v188
    v_xor_b32 v189, s97, v189
    v_xor_b32 v190, s98, v190
    v_xor_b32 v191, s99, v191
    v_or3_b32 v27, v160, v161, v162
    v_or3_b32 v28, v176, v177, v178
    v_or3_b32 v27, v27, v163, v164
    v_or3_b32 v28, v28, v179, v180
    v_or3_b32 v27, v27, v165, v166
    v_or3_b32 v28, v28, v181, v182
    v_or3_b32 v27, v27, v167, v168
    v_or3_b32 v28, v28, v183, v184
L_wm_13_sequential_p:
    s_cbranch_execz L_wm_14_sequential_p
    v_or3_b32 v27, v27, v169, v170
    v_or3_b32 v28, v28, v185, v186
    v_or3_b32 v27, v27, v171, v172
    v_or3_b32 v28, v28, v187, v188
    v_or3_b32 v27, v27, v173, v174
    v_or3_b32 v28, v28, v189, v190
    v_or3_b32 v27, v27, v175, v191
    v_or_b32 v27, v27, v28
    v_and_b32 v27, 0x1f, v27
    v_cmp_ne_u32 vcc, 0, v27
    s_or_b64 vcc, vcc, s[42:43]
    s_cbranch_scc1 L_poll_24_sequential_p
L_pto_26_sequential_p:
    v_max_f32_dpp v27, v192, v192 row_ror:1 row_mask:0xf bank_mask:0xf
    s_nop 1
    v_max_f32_dpp v27, v27, v27 row_ror:2 row_mask:0xf bank_mask:0xf
    s_nop 1
    v_max_f32_dpp v27, v27, v27 row_ror:4 row_mask:0xf bank_mask:0xf
    s_nop 1
    v_max_f32_dpp v27, v27, v27 row_ror:8 row_mask:0xf bank_mask:0xf
    v_mov_b32 v28, v27
L_wm_14_sequential_p:
    s_cbranch_execz L_wm_15_sequential_p
    s_nop 1
    v_permlane16_swap_b32 v27, v28
    v_max_f32 v27, v27, v28
    v_mov_b32 v28, v27
    s_nop 1
    v_permlane32_swap_b32 v27, v28
    v_max_f32 v27, v27, v28
    v_mul_f32 v29, s60, v27
    v_fma_f32 v192, v192, s60, -v29
    v_exp_f32 v192, v192
    s_nop 0
    v_mul_f32 v28, v192, v193
    v_mov_b32_dpp v56, v192 row_newbcast:0 row_mask:0xf bank_mask:0x3
    v_mov_b32_dpp v57, v192 row_newbcast:1 row_mask:0xf bank_mask:0x3
    v_mov_b32_dpp v58, v192 row_newbcast:2 row_mask:0xf bank_mask:0x3
    v_mov_b32_dpp v59, v192 row_newbcast:3 row_mask:0xf bank_mask:0x3
    v_mov_b32_dpp v60, v192 row_newbcast:4 row_mask:0xf bank_mask:0x3
    v_mov_b32_dpp v61, v192 row_newbcast:5 row_mask:0xf bank_mask:0x3
    v_mov_b32_dpp v62, v192 row_newbcast:6 row_mask:0xf bank_mask:0x3
    v_mov_b32_dpp v63, v192 row_newbcast:7 row_mask:0xf bank_mask:0x3
    v_mov_b32_dpp v56, v192 row_newbcast:8 row_mask:0xf bank_mask:0xc
L_wm_15_sequential_p:
    s_cbranch_execz L_wm_16_sequential_p
    v_mov_b32_dpp v57, v192 row_newbcast:9 row_mask:0xf bank_mask:0xc
    v_mov_b32_dpp v58, v192 row_newbcast:10 row_mask:0xf bank_mask:0xc
    v_mov_b32_dpp v59, v192 row_newbcast:11 row_mask:0xf bank_mask:0xc
    v_mov_b32_dpp v60, v192 row_newbcast:12 row_mask:0xf bank_mask:0xc
    v_mov_b32_dpp v61, v192 row_newbcast:13 row_mask:0xf bank_mask:0xc
    v_mov_b32_dpp v62, v192 row_newbcast:14 row_mask:0xf bank_mask:0xc
    v_mov_b32_dpp v63, v192 row_newbcast:15 row_mask:0xf bank_mask:0xc
    v_pk_mul_f32 v[48:49], v[160:161], v[56:57] op_sel:[0,0] op_sel_hi:[1,0]
    v_pk_mul_f32 v[50:51], v[162:163], v[56:57] op_sel:[0,0] op_sel_hi:[1,0]
    v_add_f32_dpp v28, v28, v28 row_ror:1 row_mask:0xf bank_mask:0xf
    v_pk_mul_f32 v[52:53], v[164:165], v[56:57] op_sel:[0,1] op_sel_hi:[1,1]
    v_pk_mul_f32 v[54:55], v[166:167], v[56:57] op_sel:[0,1] op_sel_hi:[1,1]
    v_add_f32_dpp v28, v28, v28 row_ror:2 row_mask:0xf bank_mask:0xf
    v_pk_fma_f32 v[48:49], v[168:169], v[58:59], v[48:49] op_sel:[0,0,0] op_sel_hi:[1,0,1]
    v_pk_fma_f32 v[50:51], v[170:171], v[58:59], v[50:51] op_sel:[0,0,0] op_sel_hi:[1,0,1]
    v_add_f32_dpp v28, v28, v28 row_ror:4 row_mask:0xf bank_mask:0xf
L_wm_16_sequential_p:
    s_cbranch_execz L_wm_17_sequential_p
    v_pk_fma_f32 v[52:53], v[172:173], v[58:59], v[52:53] op_sel:[0,1,0] op_sel_hi:[1,1,1]
    v_pk_fma_f32 v[54:55], v[174:175], v[58:59], v[54:55] op_sel:[0,1,0] op_sel_hi:[1,1,1]
    v_add_f32_dpp v28, v28, v28 row_ror:8 row_mask:0xf bank_mask:0xf
    v_pk_fma_f32 v[48:49], v[176:177], v[60:61], v[48:49] op_sel:[0,0,0] op_sel_hi:[1,0,1]
    v_pk_fma_f32 v[50:51], v[178:179], v[60:61], v[50:51] op_sel:[0,0,0] op_sel_hi:[1,0,1]
    v_mov_b32 v29, v28
    v_pk_fma_f32 v[52:53], v[180:181], v[60:61], v[52:53] op_sel:[0,1,0] op_sel_hi:[1,1,1]
    v_pk_fma_f32 v[54:55], v[182:183], v[60:61], v[54:55] op_sel:[0,1,0] op_sel_hi:[1,1,1]
    v_permlane16_swap_b32 v28, v29
    v_add_f32 v28, v28, v29
    v_pk_fma_f32 v[48:49], v[184:185], v[62:63], v[48:49] op_sel:[0,0,0] op_sel_hi:[1,0,1]
    v_pk_fma_f32 v[50:51], v[186:187], v[62:63], v[50:51] op_sel:[0,0,0] op_sel_hi:[1,0,1]
    v_mov_b32 v29, v28
    v_pk_fma_f32 v[52:53], v[188:189], v[62:63], v[52:53] op_sel:[0,1,0] op_sel_hi:[1,1,1]
    v_pk_fma_f32 v[54:55], v[190:191], v[62:63], v[54:55] op_sel:[0,1,0] op_sel_hi:[1,1,1]
    v_permlane32_swap_b32 v28, v29
    v_add_f32 v28, v28, v29
    v_pk_add_f32 v[48:49], v[48:49], v[52:53]
L_wm_17_sequential_p:
    s_cbranch_execz L_wm_ret_sequential_p
    v_pk_add_f32 v[50:51], v[50:51], v[54:55]
    v_rcp_f32 v28, v28
    s_nop 0
    v_permlane32_swap_b32 v48, v50
    v_permlane32_swap_b32 v49, v51
    v_pk_add_f32 v[48:49], v[48:49], v[50:51]
    s_nop 1
    v_permlane16_swap_b32 v48, v49
    v_add_f32 v48, v48, v49
    s_nop 1
    v_add_f32_dpp v48, v48, v48 row_ror:8 row_mask:0xf bank_mask:0xf
    v_mul_f32 v48, v48, v28
    v_cvt_pk_bf16_f32 v48, v48, v48
    ds_write_b16 v13, v48 offset:5376
    s_waitcnt lgkmcnt(0)
L_s2j_23_sequential_p:
    s_barrier
    ds_read_b128 v[48:51], v12 offset:5376
    s_waitcnt lgkmcnt(0)
    v_mfma_f32_16x16x32_bf16 v[64:67], v[48:51], v[96:99], 0
    v_mfma_f32_16x16x32_bf16 v[68:71], v[48:51], v[100:103], 0
    v_mfma_f32_16x16x32_bf16 v[72:75], v[48:51], v[104:107], 0
    v_mfma_f32_16x16x32_bf16 v[76:79], v[48:51], v[108:111], 0
L_wm_e3_sequential_p:
L_wm_18_sequential_p:
    s_cbranch_execz L_wm_19_sequential_p
    v_mfma_f32_16x16x32_bf16 v[80:83], v[48:51], v[112:115], 0
    v_mfma_f32_16x16x32_bf16 v[84:87], v[48:51], v[116:119], 0
    v_mfma_f32_16x16x32_bf16 v[88:91], v[48:51], v[120:123], 0
    v_mfma_f32_16x16x32_bf16 v[92:95], v[48:51], v[124:127], 0
    s_nop 1
    v_mov_b32 v65, v68
    v_mov_b32 v66, v72
    v_mov_b32 v67, v76
    v_mov_b32_dpp v64, v80 quad_perm:[0,1,2,3] row_mask:0x2 bank_mask:0xf
    v_mov_b32_dpp v65, v84 quad_perm:[0,1,2,3] row_mask:0x2 bank_mask:0xf
    v_mov_b32_dpp v66, v88 quad_perm:[0,1,2,3] row_mask:0x2 bank_mask:0xf
    v_mov_b32_dpp v67, v92 quad_perm:[0,1,2,3] row_mask:0x2 bank_mask:0xf
    v_and_or_b32 v64, v64, s95, v228
    v_and_or_b32 v65, v65, s95, v229
    v_and_or_b32 v66, v66, s95, v230
    v_and_or_b32 v67, v67, s95, v231
    s_mov_b32 exec_hi, 0
    buffer_store_dwordx4 v[64:67], v11, s[36:39], s54 offen sc1
L_wm_19_sequential_p:
    s_cbranch_execz L_wm_20_sequential_p
    s_mov_b64 exec, -1
    s_cmp_lt_u32 s41, 8
    s_cbranch_scc1 L_red_19_sequential_p
    s_branch L_fin_18_sequential_p
L_ffn_17_sequential_p:
    s_barrier
    s_add_u32 s50, s46, 0
    buffer_load_dwordx4 v[128:131], v7, s[24:27], s50 offen nt
    s_add_u32 s50, s46, 7168
    buffer_load_dwordx4 v[132:135], v7, s[24:27], s50 offen nt
    s_add_u32 s50, s46, 14336
    buffer_load_dwordx4 v[136:139], v7, s[24:27], s50 offen nt
    s_add_u32 s50, s46, 21504
    buffer_load_dwordx4 v[140:143], v7, s[24:27], s50 offen nt
    s_add_u32 s50, s46, 28672
    buffer_load_dwordx4 v[144:147], v7, s[24:27], s50 offen nt
    s_add_u32 s50, s46, 35840
    buffer_load_dwordx4 v[148:151], v7, s[24:27], s50 offen nt
    s_add_u32 s50, s46, 43008
L_wm_20_sequential_p:
    s_cbranch_execz L_wm_21_sequential_p
    buffer_load_dwordx4 v[152:155], v7, s[24:27], s50 offen nt
    s_add_u32 s50, s46, 50176
    buffer_load_dwordx4 v[156:159], v7, s[24:27], s50 offen nt
    s_waitcnt vmcnt(3)
    buffer_load_dwordx4 v[192:195], v8, s[28:31], s47 offen offset:0 nt
    buffer_load_dwordx4 v[196:199], v8, s[28:31], s47 offen offset:2048 nt
    s_add_u32 s47, s47, 4096
    buffer_load_dwordx4 v[200:203], v8, s[28:31], s47 offen offset:0 nt
    buffer_load_dwordx4 v[204:207], v8, s[28:31], s47 offen offset:2048 nt
    s_add_u32 s47, s47, 4096
    buffer_load_dwordx4 v[208:211], v8, s[28:31], s47 offen offset:0 nt
    buffer_load_dwordx4 v[212:215], v8, s[28:31], s47 offen offset:2048 nt
    s_add_u32 s47, s47, 4096
    buffer_load_dwordx4 v[216:219], v8, s[28:31], s47 offen offset:0 nt
    buffer_load_dwordx4 v[220:223], v8, s[28:31], s47 offen offset:2048 nt
    v_lshrrev_b32 v9, 1, v1
    v_lshlrev_b32 v9, 4, v9
L_wm_21_sequential_p:
    s_cbranch_execz L_wm_22_sequential_p
    s_lshl_b32 s48, s3, 9
    s_add_u32 s48, s48, 0x400000
    v_lshrrev_b32 v10, 5, v1
    v_lshlrev_b32 v10, 5, v10
    s_lshl_b32 s49, s3, 2
    v_add_u32 v10, s49, v10
    v_and_b32 v13, 7, v1
    v_lshlrev_b32 v13, 2, v13
    s_mov_b32 s49, 0x43000000
    s_mov_b32 s52, 0xaaaaaaaa
    s_mov_b32 s53, 0xaaaaaaaa
    s_waitcnt vmcnt(8)
    v_perm_b32 v96, v132, v128, s62
    v_perm_b32 v97, v140, v136, s62
    v_perm_b32 v98, v148, v144, s62
    v_perm_b32 v99, v156, v152, s62
    v_perm_b32 v100, v132, v128, s63
    v_perm_b32 v101, v140, v136, s63
    v_perm_b32 v102, v148, v144, s63
    v_perm_b32 v103, v156, v152, s63
L_wm_22_sequential_p:
    s_cbranch_execz L_wm_23_sequential_p
    v_perm_b32 v104, v133, v129, s62
    v_perm_b32 v105, v141, v137, s62
    v_perm_b32 v106, v149, v145, s62
    v_perm_b32 v107, v157, v153, s62
    v_perm_b32 v108, v133, v129, s63
    v_perm_b32 v109, v141, v137, s63
    v_perm_b32 v110, v149, v145, s63
    v_perm_b32 v111, v157, v153, s63
    v_perm_b32 v112, v134, v130, s62
    v_perm_b32 v113, v142, v138, s62
    v_perm_b32 v114, v150, v146, s62
    v_perm_b32 v115, v158, v154, s62
    v_perm_b32 v116, v134, v130, s63
    v_perm_b32 v117, v142, v138, s63
    v_perm_b32 v118, v150, v146, s63
L_wm_23_sequential_p:
    s_cbranch_execz L_wm_ret_sequential_p
    v_perm_b32 v119, v158, v154, s63
    v_perm_b32 v120, v135, v131, s62
    v_perm_b32 v121, v143, v139, s62
    v_perm_b32 v122, v151, v147, s62
    v_perm_b32 v123, v159, v155, s62
    v_perm_b32 v124, v135, v131, s63
    v_perm_b32 v125, v143, v139, s63
    v_perm_b32 v126, v151, v147, s63
    v_perm_b32 v127, v159, v155, s63
    s_waitcnt vmcnt(0)
    v_perm_b32 v160, v196, v192, s62
    v_perm_b32 v161, v204, v200, s62
    v_perm_b32 v162, v212, v208, s62
    v_perm_b32 v163, v220, v216, s62
    v_perm_b32 v164, v196, v192, s63
    v_perm_b32 v165, v204, v200, s63
L_wm_e4_sequential_p:
L_wm_24_sequential_p:
    s_cbranch_execz L_wm_25_sequential_p
    v_perm_b32 v166, v212, v208, s63
    v_perm_b32 v167, v220, v216, s63
    v_perm_b32 v168, v197, v193, s62
    v_perm_b32 v169, v205, v201, s62
    v_perm_b32 v170, v213, v209, s62
    v_perm_b32 v171, v221, v217, s62
    v_perm_b32 v172, v197, v193, s63
    v_perm_b32 v173, v205, v201, s63
    v_perm_b32 v174, v213, v209, s63
    v_perm_b32 v175, v221, v217, s63
    v_perm_b32 v176, v198, v194, s62
    v_perm_b32 v177, v206, v202, s62
    v_perm_b32 v178, v214, v210, s62
    v_perm_b32 v179, v222, v218, s62
    v_perm_b32 v180, v198, v194, s63
    v_perm_b32 v181, v206, v202, s63
L_wm_25_sequential_p:
    s_cbranch_execz L_wm_26_sequential_p
    v_perm_b32 v182, v214, v210, s63
    v_perm_b32 v183, v222, v218, s63
    v_perm_b32 v184, v199, v195, s62
    v_perm_b32 v185, v207, v203, s62
    v_perm_b32 v186, v215, v211, s62
    v_perm_b32 v187, v223, v219, s62
    v_perm_b32 v188, v199, v195, s63
    v_perm_b32 v189, v207, v203, s63
    v_perm_b32 v190, v215, v211, s63
    v_perm_b32 v191, v223, v219, s63
    s_mov_b32 s65, 0
L_poll_27_sequential_p:
    buffer_load_dwordx4 v[64:67], v9, s[36:39], s48 offen sc1
    s_add_u32 s65, s65, 1
    s_cmp_ge_u32 s65, 262144
    s_cbranch_scc1 L_pto_29_sequential_p
L_pw_28_sequential_p:
    s_waitcnt vmcnt(0)
    v_cmp_ne_u64 vcc, s[68:69], v[66:67]
    s_cbranch_vccnz L_poll_27_sequential_p
L_pto_29_sequential_p:
L_wm_26_sequential_p:
    s_cbranch_execz L_wm_27_sequential_p
    v_cndmask_b32 v32, v64, v65, s[52:53]
    v_lshlrev_b32 v48, 16, v32
    v_and_b32 v49, s64, v32
    v_readfirstlane_b32 s55, v48
    s_nop 1
    v_subrev_f32 v56, s55, v48
    v_subrev_f32 v57, s55, v49
    v_add_f32 v27, v56, v57
    v_mul_f32 v28, v56, v56
    v_fmac_f32 v28, v57, v57
    v_mov_b32 v30, s55
    s_nop 0
    v_permlane32_swap_b32 v27, v28
    v_add_f32 v27, v27, v28
    v_mov_b32 v28, v27
    s_nop 1
    v_permlane16_swap_b32 v27, v28
    v_add_f32 v27, v27, v28
    s_nop 1
    v_add_f32_dpp v27, v27, v27 row_ror:1 row_mask:0xf bank_mask:0xf
    s_nop 1
    v_add_f32_dpp v27, v27, v27 row_ror:2 row_mask:0xf bank_mask:0xf
    s_nop 1
    v_add_f32_dpp v27, v27, v27 row_ror:4 row_mask:0xf bank_mask:0xf
    s_nop 1
    v_add_f32_dpp v27, v27, v27 row_ror:8 row_mask:0xf bank_mask:0xf
L_wm_27_sequential_p:
    s_cbranch_execz L_wm_28_sequential_p
    s_mov_b64 exec, 1
    ds_write_b32 v10, v30 offset:4672
    s_mov_b32 exec_hi, 1
    ds_write_b32 v10, v27 offset:4608
    s_mov_b64 exec, -1
    s_waitcnt lgkmcnt(0)
    s_barrier
    ds_read_b32 v27, v13 offset:4608
    ds_read_b32 v29, v13 offset:4672
    ds_read_b32 v28, v13 offset:4640
    s_waitcnt lgkmcnt(1)
    v_fma_f32 v30, v29, s49, v27
    s_nop 1
    v_add_f32_dpp v30, v30, v30 row_ror:1 row_mask:0xf bank_mask:0xf
    s_nop 1
    v_add_f32_dpp v30, v30, v30 row_ror:2 row_mask:0xf bank_mask:0xf
    s_nop 1
    v_add_f32_dpp v30, v30, v30 row_ror:4 row_mask:0xf bank_mask:0xf
    v_mul_f32 v30, 0x3a800000, v30
    v_sub_f32 v29, v30, v29
    v_mul_f32 v31, s49, v29
L_wm_28_sequential_p:
    s_cbranch_execz L_wm_29_sequential_p
    v_fma_f32 v31, -2.0, v27, v31
    s_waitcnt lgkmcnt(0)
    v_fmac_f32 v28, v29, v31
    s_nop 1
    v_add_f32_dpp v28, v28, v28 row_ror:1 row_mask:0xf bank_mask:0xf
    s_nop 1
    v_add_f32_dpp v28, v28, v28 row_ror:2 row_mask:0xf bank_mask:0xf
    s_nop 1
    v_add_f32_dpp v28, v28, v28 row_ror:4 row_mask:0xf bank_mask:0xf
    v_mul_f32 v28, 0x3a800000, v28
    v_cvt_pk_bf16_f32 v27, v30, v28
    v_lshlrev_b32 v30, 16, v27
    v_and_b32 v28, s64, v27
    v_add_f32 v28, 0x3727c5ac, v28
    v_cvt_pk_bf16_f32 v27, v28, v28
    v_lshlrev_b32 v28, 16, v27
    v_sqrt_f32 v29, v28
    s_nop 0
    v_cvt_pk_bf16_f32 v27, v29, v29
    v_lshlrev_b32 v29, 16, v27
    v_rcp_f32 v31, v29
    v_sub_f32 v48, v48, v30
L_wm_29_sequential_p:
    s_cbranch_execz L_wm_ret_sequential_p
    v_sub_f32 v49, v49, v30
    v_cvt_pk_bf16_f32 v56, v48, v49
    v_lshlrev_b32 v48, 16, v56
    v_and_b32 v49, s64, v56
    v_mul_f32 v56, v48, v31
    v_mul_f32 v57, v49, v31
    v_fma_f32 v48, -v56, v29, v48
    v_fma_f32 v49, -v57, v29, v49
    v_fma_f32 v48, v48, v31, v56
    v_fma_f32 v49, v49, v31, v57
    v_cvt_pk_bf16_f32 v27, v48, v49
    s_nop 1
    v_mov_b32_dpp v56, v27 quad_perm:[0,0,0,0] row_mask:0xf bank_mask:0xf
    v_mov_b32_dpp v57, v27 quad_perm:[1,1,1,1] row_mask:0xf bank_mask:0xf
    v_mov_b32_dpp v58, v27 quad_perm:[2,2,2,2] row_mask:0xf bank_mask:0xf
    v_mov_b32_dpp v59, v27 quad_perm:[3,3,3,3] row_mask:0xf bank_mask:0xf
    s_nop 1
    v_mfma_f32_16x16x32_bf16 v[64:67], v[56:59], v[96:99], 0
    v_mfma_f32_16x16x32_bf16 v[68:71], v[56:59], v[100:103], 0
L_wm_e5_sequential_p:
L_wm_30_sequential_p:
    s_cbranch_execz L_wm_31_sequential_p
    v_mfma_f32_16x16x32_bf16 v[72:75], v[56:59], v[104:107], 0
    v_mfma_f32_16x16x32_bf16 v[76:79], v[56:59], v[108:111], 0
    v_mfma_f32_16x16x32_bf16 v[80:83], v[56:59], v[112:115], 0
    v_mfma_f32_16x16x32_bf16 v[84:87], v[56:59], v[116:119], 0
    v_mfma_f32_16x16x32_bf16 v[88:91], v[56:59], v[120:123], 0
    v_mfma_f32_16x16x32_bf16 v[92:95], v[56:59], v[124:127], 0
    s_mov_b32 exec_lo, 0x00f0000f
    s_mov_b32 exec_hi, 0xf0000f00
    v_mov_b32 v65, v68
    v_mov_b32 v66, v72
    v_mov_b32 v67, v76
    ds_write_b128 v15, v[64:67] offset:4864
    v_mov_b32 v81, v84
    v_mov_b32 v82, v88
    v_mov_b32 v83, v92
    ds_write_b128 v15, v[80:83] offset:4880
    s_mov_b64 exec, -1
    s_waitcnt lgkmcnt(0)
    s_barrier
    ds_read_b128 v[32:35], v14 offset:4864
L_wm_31_sequential_p:
    s_cbranch_execz L_wm_32_sequential_p
    ds_read_b128 v[36:39], v14 offset:6016
    ds_read_b128 v[40:43], v14 offset:7168
    ds_read_b128 v[44:47], v14 offset:8320
    s_waitcnt lgkmcnt(2)
    v_pk_add_f32 v[32:33], v[32:33], v[36:37]
    v_pk_add_f32 v[34:35], v[34:35], v[38:39]
    s_waitcnt lgkmcnt(0)
    v_pk_add_f32 v[40:41], v[40:41], v[44:45]
    v_pk_add_f32 v[42:43], v[42:43], v[46:47]
    v_pk_add_f32 v[48:49], v[32:33], v[40:41]
    v_pk_add_f32 v[50:51], v[34:35], v[42:43]
    s_nop 0
    v_add_f32_dpp v48, v48, v48 quad_perm:[1,0,3,2] row_mask:0xf bank_mask:0xf
    v_add_f32_dpp v49, v49, v49 quad_perm:[1,0,3,2] row_mask:0xf bank_mask:0xf
    v_add_f32_dpp v50, v50, v50 quad_perm:[1,0,3,2] row_mask:0xf bank_mask:0xf
    v_add_f32_dpp v51, v51, v51 quad_perm:[1,0,3,2] row_mask:0xf bank_mask:0xf
    v_add_f32_dpp v48, v48, v48 quad_perm:[2,3,0,1] row_mask:0xf bank_mask:0xf
L_wm_32_sequential_p:
    s_cbranch_execz L_wm_33_sequential_p
    v_add_f32_dpp v49, v49, v49 quad_perm:[2,3,0,1] row_mask:0xf bank_mask:0xf
    v_add_f32_dpp v50, v50, v50 quad_perm:[2,3,0,1] row_mask:0xf bank_mask:0xf
    v_add_f32_dpp v51, v51, v51 quad_perm:[2,3,0,1] row_mask:0xf bank_mask:0xf
    v_add_f32_dpp v48, v48, v48 row_half_mirror row_mask:0xf bank_mask:0xf
    v_add_f32_dpp v49, v49, v49 row_half_mirror row_mask:0xf bank_mask:0xf
    v_add_f32_dpp v50, v50, v50 row_half_mirror row_mask:0xf bank_mask:0xf
    v_add_f32_dpp v51, v51, v51 row_half_mirror row_mask:0xf bank_mask:0xf
    v_cvt_pk_bf16_f32 v27, v48, v49
    v_cvt_pk_bf16_f32 v28, v50, v51
    v_lshlrev_b32 v48, 16, v27
    v_and_b32 v49, s64, v27
    v_lshlrev_b32 v50, 16, v28
    v_and_b32 v51, s64, v28
    v_mul_f32 v56, s60, v48
    v_mul_f32 v57, s60, v49
    v_mul_f32 v58, s60, v50
    v_mul_f32 v59, s60, v51
    v_exp_f32 v56, -v56
    v_exp_f32 v57, -v57
    v_exp_f32 v58, -v58
L_wm_33_sequential_p:
    s_cbranch_execz L_wm_34_sequential_p
    v_exp_f32 v59, -v59
    v_add_f32 v56, 1.0, v56
    v_add_f32 v57, 1.0, v57
    v_add_f32 v58, 1.0, v58
    v_add_f32 v59, 1.0, v59
    v_rcp_f32 v56, v56
    v_rcp_f32 v57, v57
    v_rcp_f32 v58, v58
    v_rcp_f32 v59, v59
    v_mul_f32 v48, v48, v56
    v_mul_f32 v49, v49, v57
    v_mul_f32 v50, v50, v58
    v_mul_f32 v51, v51, v59
    v_cvt_pk_bf16_f32 v56, v48, v49
    v_cvt_pk_bf16_f32 v57, v50, v51
    v_cvt_pk_bf16_f32 v58, v48, v49
    v_cvt_pk_bf16_f32 v59, v50, v51
    v_mov_b32_dpp v56, v56 row_ror:8 row_mask:0xf bank_mask:0xc
    v_mov_b32_dpp v57, v57 row_ror:8 row_mask:0xf bank_mask:0xc
    v_mov_b32_dpp v58, v58 row_ror:8 row_mask:0xf bank_mask:0x3
    v_mov_b32_dpp v59, v59 row_ror:8 row_mask:0xf bank_mask:0x3
L_wm_34_sequential_p:
    s_cbranch_execz L_wm_35_sequential_p
    s_nop 1
    v_mfma_f32_16x16x32_bf16 v[64:67], v[56:59], v[160:163], 0
    v_mfma_f32_16x16x32_bf16 v[68:71], v[56:59], v[164:167], 0
    v_mfma_f32_16x16x32_bf16 v[72:75], v[56:59], v[168:171], 0
    v_mfma_f32_16x16x32_bf16 v[76:79], v[56:59], v[172:175], 0
    v_mfma_f32_16x16x32_bf16 v[80:83], v[56:59], v[176:179], 0
    v_mfma_f32_16x16x32_bf16 v[84:87], v[56:59], v[180:183], 0
    v_mfma_f32_16x16x32_bf16 v[88:91], v[56:59], v[184:187], 0
    v_mfma_f32_16x16x32_bf16 v[92:95], v[56:59], v[188:191], 0
    s_nop 1
    v_mov_b32 v65, v68
    v_mov_b32 v66, v72
    v_mov_b32 v67, v76
    v_mov_b32_dpp v64, v80 quad_perm:[0,1,2,3] row_mask:0x2 bank_mask:0xf
    v_mov_b32_dpp v65, v84 quad_perm:[0,1,2,3] row_mask:0x2 bank_mask:0xf
    v_mov_b32_dpp v66, v88 quad_perm:[0,1,2,3] row_mask:0x2 bank_mask:0xf
    v_mov_b32_dpp v67, v92 quad_perm:[0,1,2,3] row_mask:0x2 bank_mask:0xf
    v_and_or_b32 v64, v64, s95, v228
L_wm_35_sequential_p:
    s_cbranch_execz L_wm_ret_sequential_p
    v_and_or_b32 v65, v65, s95, v229
    v_and_or_b32 v66, v66, s95, v230
    v_and_or_b32 v67, v67, s95, v231
    s_mov_b32 exec_hi, 0
    buffer_store_dwordx4 v[64:67], v11, s[36:39], s54 offen sc1
    s_mov_b64 exec, -1
    s_branch L_fin_18_sequential_p
L_red_19_sequential_p:
    s_lshl_b32 s48, s45, 3
    s_add_u32 s55, s41, s48
    v_and_b32 v9, 31, v1
    v_lshlrev_b32 v10, 1, v9
    s_lshl_b32 s48, s55, 6
    buffer_load_ushort v15, v10, s[4:7], s48 offen
    v_lshlrev_b32 v13, 2, v9
    v_lshrrev_b32 v14, 5, v1
    v_lshl_add_u32 v14, v14, 7, v13
    v_lshrrev_b32 v9, 3, v1
    v_lshlrev_b32 v9, 12, v9
    v_and_b32 v12, 7, v1
    v_lshl_add_u32 v9, v12, 4, v9
    v_lshlrev_b32 v12, 4, v12
    v_lshl_add_u32 v12, v2, 2, v12
    s_lshl_b32 s48, s3, 7
L_wm_e6_sequential_p:
L_wm_36_sequential_p:
    s_cbranch_execz L_wm_37_sequential_p
    v_add_u32 v12, s48, v12
    s_lshl_b32 s48, s3, 16
    s_lshl_b32 s49, s55, 7
    s_add_u32 s48, s48, s49
    s_add_u32 s48, s48, 0x300000
    s_add_u32 s49, s48, 0x8000
    s_add_u32 s50, s48, 0x80000
    s_add_u32 s52, s48, 0x88000
    s_lshl_b32 s54, s55, 7
    s_add_u32 s54, s54, 0x400000
    s_lshl_b32 s53, s55, 6
    v_mov_b32 v58, s68
    v_mov_b32 v59, s69
    s_waitcnt vmcnt(0)
    s_mov_b32 s65, 0
L_poll_30_sequential_p:
    buffer_load_dwordx4 v[96:99], v9, s[36:39], s48 offen sc1
    buffer_load_dwordx4 v[100:103], v9, s[36:39], s49 offen sc1
    s_add_u32 s65, s65, 1
    s_cmp_ge_u32 s65, 262144
    s_cbranch_scc1 L_pto_32_sequential_p
L_pw_31_sequential_p:
    s_waitcnt vmcnt(0)
    v_xor_b32 v96, s96, v96
    v_xor_b32 v97, s97, v97
L_wm_37_sequential_p:
    s_cbranch_execz L_wm_38_sequential_p
    v_xor_b32 v98, s98, v98
    v_xor_b32 v99, s99, v99
    v_xor_b32 v100, s96, v100
    v_xor_b32 v101, s97, v101
    v_xor_b32 v102, s98, v102
    v_xor_b32 v103, s99, v103
    v_or3_b32 v32, v96, v97, v98
    v_or3_b32 v33, v100, v101, v102
    v_or3_b32 v32, v32, v99, v103
    v_or_b32 v32, v32, v33
    v_and_b32 v32, 0x1f, v32
    v_cmp_ne_u32 vcc, 0, v32
    s_cbranch_vccnz L_poll_30_sequential_p
L_pto_32_sequential_p:
    v_pk_add_f32 v[64:65], v[96:97], v[100:101]
    v_pk_add_f32 v[66:67], v[98:99], v[102:103]
    s_nop 1
    v_permlane32_swap_b32 v64, v66
    v_permlane32_swap_b32 v65, v67
    v_pk_add_f32 v[64:65], v[64:65], v[66:67]
    s_nop 1
    v_permlane16_swap_b32 v64, v65
    v_add_f32 v64, v64, v65
    s_nop 1
    v_add_f32_dpp v64, v64, v64 row_ror:8 row_mask:0xf bank_mask:0xf
L_wm_38_sequential_p:
    s_cbranch_execz L_wm_39_sequential_p
    ds_write_b32 v12, v64 offset:5632
    v_lshlrev_b32 v15, 16, v15
    s_waitcnt lgkmcnt(0)
    s_barrier
    s_cmp_lg_u32 s3, 0
    s_cbranch_scc1 L_r1_33_sequential_p
    ds_read_b32 v64, v14 offset:5632
    ds_read_b32 v65, v14 offset:5888
    ds_read_b32 v66, v14 offset:6144
    ds_read_b32 v67, v14 offset:6400
    s_waitcnt lgkmcnt(0)
    v_pk_add_f32 v[64:65], v[64:65], v[66:67]
    v_add_f32 v64, v64, v65
    v_mov_b32 v65, v64
    s_nop 1
    v_permlane32_swap_b32 v64, v65
    v_add_f32 v64, v64, v65
    v_cvt_pk_bf16_f32 v27, v64, v64
    v_lshlrev_b32 v64, 16, v27
    v_add_f32 v15, v15, v64
    v_cvt_pk_bf16_f32 v27, v15, v15
    v_lshlrev_b32 v15, 16, v27
    s_nop 1
L_wm_39_sequential_p:
    s_cbranch_execz L_wm_40_sequential_p
    v_mov_b32_dpp v28, v15 quad_perm:[1,1,3,3] row_mask:0xf bank_mask:0xf
    v_perm_b32 v56, v28, v15, s63
    s_nop 1
    v_mov_b32_dpp v57, v56 quad_perm:[2,2,2,2] row_mask:0xf bank_mask:0xf
    s_mov_b32 exec_lo, 0x11111111
    s_mov_b32 exec_hi, 0
    buffer_store_dwordx4 v[56:59], v13, s[36:39], s54 offen sc1
    s_mov_b64 exec, -1
L_r1_33_sequential_p:
    s_cmp_eq_u32 s3, 7
    s_cbranch_scc1 L_r7_34_sequential_p
    s_mov_b32 s65, 0
L_poll_36_sequential_p:
    buffer_load_dwordx4 v[104:107], v9, s[36:39], s50 offen sc1
    buffer_load_dwordx4 v[108:111], v9, s[36:39], s52 offen sc1
    s_add_u32 s65, s65, 1
    s_cmp_ge_u32 s65, 262144
    s_cbranch_scc1 L_pto_38_sequential_p
L_pw_37_sequential_p:
    s_waitcnt vmcnt(0)
    v_xor_b32 v104, s96, v104
    v_xor_b32 v105, s97, v105
    v_xor_b32 v106, s98, v106
    v_xor_b32 v107, s99, v107
    v_xor_b32 v108, s96, v108
    v_xor_b32 v109, s97, v109
L_wm_40_sequential_p:
    s_cbranch_execz L_wm_41_sequential_p
    v_xor_b32 v110, s98, v110
    v_xor_b32 v111, s99, v111
    v_or3_b32 v32, v104, v105, v106
    v_or3_b32 v33, v108, v109, v110
    v_or3_b32 v32, v32, v107, v111
    v_or_b32 v32, v32, v33
    v_and_b32 v32, 0x1f, v32
    v_cmp_ne_u32 vcc, 0, v32
    s_cbranch_vccnz L_poll_36_sequential_p
L_pto_38_sequential_p:
    v_pk_add_f32 v[64:65], v[104:105], v[108:109]
    v_pk_add_f32 v[66:67], v[106:107], v[110:111]
    s_nop 1
    v_permlane32_swap_b32 v64, v66
    v_permlane32_swap_b32 v65, v67
    v_pk_add_f32 v[64:65], v[64:65], v[66:67]
    s_nop 1
    v_permlane16_swap_b32 v64, v65
    v_add_f32 v64, v64, v65
    s_nop 1
    v_add_f32_dpp v64, v64, v64 row_ror:8 row_mask:0xf bank_mask:0xf
    ds_write_b32 v12, v64 offset:6656
    s_branch L_r8_35_sequential_p
L_r7_34_sequential_p:
    v_mov_b32 v64, 0
L_wm_41_sequential_p:
    s_cbranch_execz L_wm_ret_sequential_p
    ds_write_b32 v12, v64 offset:6656
L_r8_35_sequential_p:
    s_waitcnt lgkmcnt(0)
    s_barrier
    s_cmp_lg_u32 s3, 0
    s_cbranch_scc1 L_fin_18_sequential_p
    ds_read_b32 v64, v14 offset:6656
    ds_read_b32 v65, v14 offset:6912
    ds_read_b32 v66, v14 offset:7168
    ds_read_b32 v67, v14 offset:7424
    s_waitcnt lgkmcnt(0)
    v_pk_add_f32 v[64:65], v[64:65], v[66:67]
    v_add_f32 v64, v64, v65
    v_mov_b32 v65, v64
    s_nop 1
    v_permlane32_swap_b32 v64, v65
    v_add_f32 v64, v64, v65
    v_cvt_pk_bf16_f32 v27, v64, v64
    v_lshlrev_b32 v64, 16, v27
    v_add_f32 v15, v15, v64
    v_cvt_pk_bf16_f32 v15, v15, v15
    s_mov_b32 exec_hi, 0
    buffer_store_short v15, v10, s[32:35], s53 offen
L_wm_e7_sequential_p:
L_wm_42_sequential_p:
    s_cbranch_execz L_wm_ret_sequential_p
    s_cmp_lg_u32 s55, 0
    s_cbranch_scc1 L_ep_39_sequential_p
    s_mov_b64 exec, 1
    v_mov_b32 v30, s68
    v_mov_b32 v31, s69
    v_mov_b32 v9, 0
    s_mov_b32 s48, 0x480000
    buffer_store_dwordx2 v[30:31], v9, s[36:39], s48 offen sc1
L_ep_39_sequential_p:
L_fin_18_sequential_p:
L_end_1_sequential_p:
    s_endpgm
.section .rodata,"a"
.p2align 6
.amdhsa_kernel sequential_preLN__gqa_block_cached__dense_activation_silu__decode_kernel
  .amdhsa_next_free_vgpr 256
  .amdhsa_next_free_sgpr 102
  .amdhsa_accum_offset 256
  .amdhsa_group_segment_fixed_size 0
  .amdhsa_kernarg_size 88
  .amdhsa_user_sgpr_count 2
  .amdhsa_user_sgpr_kernarg_segment_ptr 1
  .amdhsa_system_sgpr_workgroup_id_x 1
.end_amdhsa_kernel
```
